```python
import torch

def _softmax(x, axis=-1):
    return torch.softmax(x, dim=axis)
def _gelu(x):
    return torch.nn.functional.gelu(x, approximate="tanh")
def _silu(x):
    return torch.nn.functional.silu(x)
def _sigmoid(x):
    return torch.sigmoid(x)
def _layernorm(x, axis=-1, eps=1e-5):
    m = x.mean(dim=axis, keepdim=True)
    v = x.var(dim=axis, keepdim=True, unbiased=False)
    return (x - m) / torch.sqrt(v + eps)
def _scatter_add(tgt, idx, src, axis=0):
    return tgt.clone().index_add_(axis, idx, src)
def _segment_sum(src, seg, n):
    out = torch.zeros((n,) + src.shape[1:], dtype=src.dtype)
    return out.index_add_(0, seg, src)
def _pad(x, pw):
    flat = tuple(v for pair in reversed(pw) for v in pair)
    return torch.nn.functional.pad(x, flat)

kernel_name = 'recurrent_scan__gqa_block_cached__mixer_channel_mlp__decode'

def setup_inputs():

    _w = (lambda a: (lambda t: t.to(torch.bfloat16) if t.is_floating_point() else t)(torch.as_tensor(a)))
    def _A_setup():
        B, Sq, D = 1, 1, 640
        Hq, Hkv, Sk, Dh = 32, 32, 8192, 192
        assert Hq % Hkv == 0, (Hq, Hkv)
        return {
            "x": _w((lambda *s: torch.randn(*s, dtype=torch.bfloat16) * 0.05)(B, Sq, D)),
            "k_cache": _w((lambda *s: torch.randn(*s, dtype=torch.bfloat16) * 1.6)(B, Hkv, Sk, Dh)),
            "v_cache": _w((lambda *s: torch.randn(*s, dtype=torch.bfloat16) * 1.6)(B, Hkv, Sk, Dh)),
            "wq": _w((lambda *s: torch.randn(*s, dtype=torch.bfloat16) * 1.6)(D, Hq * Dh) * (D ** -0.5)),
            "wo": _w((lambda *s: torch.randn(*s, dtype=torch.bfloat16) * 1.6)(Hq * Dh, D) * ((Hq * Dh) ** -0.5)),
        }
    _A_in = _A_setup()

    def _B_setup():
        B, S, D, F = 1, 1, 640, 1536
        return {
            "x": _w((lambda *s: torch.randn(*s, dtype=torch.bfloat16) * 0.05)(B, S, D)),
            "w1": _w((lambda *s: torch.randn(*s, dtype=torch.bfloat16) * 0.8)(D, F) * (D ** -0.5)),
            "b1": _w((lambda *s: torch.randn(*s, dtype=torch.bfloat16) * 0.4)(F)),
            "w2": _w((lambda *s: torch.randn(*s, dtype=torch.bfloat16) * 0.4)(F, D) * (F ** -0.5)),
            "b2": _w((lambda *s: torch.randn(*s, dtype=torch.bfloat16) * 0.2)(D)),
        }
    _B_in = _B_setup()

    return {
        "A_x": _A_in["x"],
        "A_k_cache": _A_in["k_cache"],
        "A_v_cache": _A_in["v_cache"],
        "A_wq": _A_in["wq"],
        "A_wo": _A_in["wo"],
        "B_x": _B_in["x"],
        "B_w1": _B_in["w1"],
        "B_b1": _B_in["b1"],
        "B_w2": _B_in["w2"],
        "B_b2": _B_in["b2"],
    }

def reference(A_x, A_k_cache, A_v_cache, A_wq, A_wo, B_x, B_w1, B_b1, B_w2, B_b2):
    def _A_ref(x, k_cache, v_cache, wq, wo):
        B, Sq, D = x.shape
        Hq, Dh = 32, 192
        Hkv = k_cache.shape[1]
        rep = Hq // Hkv
        q = (lambda x, *d: x.permute(*d))((x @ wq).reshape(B, Sq, Hq, Dh), 0, 2, 1, 3)
        k = (lambda x, n, axis: torch.repeat_interleave(x, n, dim=axis))(k_cache, rep, axis=1)
        v = (lambda x, n, axis: torch.repeat_interleave(x, n, dim=axis))(v_cache, rep, axis=1)
        scores = torch.einsum("bhqd,bhkd->bhqk", q, k) * (Dh ** -0.5)
        p = _softmax(scores, axis=-1)
        o = torch.einsum("bhqk,bhkd->bhqd", p, v)
        return (lambda x, *d: x.permute(*d))(o, 0, 2, 1, 3).reshape(B, Sq, Hq * Dh) @ wo

    def _B_ref(x, w1, b1, w2, b2):
        y = _layernorm(x, axis=-1)
        h = _gelu(torch.einsum("bsd,df->bsf", y, w1) + b1)
        return torch.einsum("bsf,fd->bsd", h, w2) + b2

    x = A_x
    xn = _layernorm(x, axis=-1)
    s = _A_ref(xn, A_k_cache, A_v_cache, A_wq, A_wo)
    g = _silu(_B_ref(xn, B_w1, B_b1, B_w2, B_b2))
    return x + s * g
```

```asm
; @launch grid=(256,1,1) block=(512,1,1) lds=135680
.amdgcn_target "amdgcn-amd-amdhsa--gfx950"
.text
    .globl recurrent_scan__gqa_block_cached__mixer_channel_mlp__decode_kernel
    .p2align 8
    .type recurrent_scan__gqa_block_cached__mixer_channel_mlp__decode_kernel,@function
recurrent_scan__gqa_block_cached__mixer_channel_mlp__decode_kernel:
    s_cmp_ge_u32 s2, 256
    s_cbranch_scc1 L_done
    s_load_dwordx4 s[64:67], s[0:1], 0
    s_load_dwordx4 s[68:71], s[0:1], 16
    s_load_dwordx2 s[72:73], s[0:1], 32
    s_load_dwordx4 s[76:79], s[0:1], 48
    s_load_dwordx4 s[80:83], s[0:1], 64
    s_load_dwordx4 s[84:87], s[0:1], 80
    s_load_dwordx2 s[88:89], s[0:1], 96
    v_lshrrev_b32 v1, 6, v0
    s_nop 0
    v_readfirstlane_b32 s10, v1
    v_and_b32 v1, 63, v0
    s_lshr_b32 s11, s2, 3
    s_and_b32 s12, s2, 7
    s_mul_i32 s13, s11, 3145728
    v_and_b32 v2, 15, v1
    v_mul_u32_u24 v2, 384, v2
    v_lshrrev_b32 v3, 4, v1
    v_lshlrev_b32 v3, 4, v3
    v_add_u32 v2, v2, v3
    v_lshlrev_b32 v185, 4, v1
    v_add_u32 v184, 4096, v185
    v_mov_b32 v5, 0x40000000
    v_cmp_gt_u32 vcc, 48, v1
    s_nop 1
    v_cndmask_b32 v4, v5, v185, vcc
    v_add_u32 v6, 3072, v4
    v_mul_u32_u24 v154, 171, v0
    v_lshrrev_b32 v180, 12, v154
    v_mul_u32_u24 v155, 24, v180
    v_sub_u32 v181, v0, v155
    v_lshrrev_b32 v154, 10, v154
    v_mul_u32_u24 v155, 6, v154
    v_sub_u32 v171, v0, v155
    v_mul_u32_u24 v186, 3072, v154
    v_lshlrev_b32 v155, 4, v171
    v_add_u32 v186, v186, v155
    v_lshlrev_b32 v187, 2, v154
    s_mov_b32 s14, 12288
    v_mul_lo_u32 v7, v180, s14
    v_lshlrev_b32 v155, 4, v181
    v_add_u32 v7, v7, v155
    v_mov_b32 v5, 0x40000000
    v_cmp_gt_u32 vcc, 480, v0
    s_nop 1
    v_cndmask_b32 v7, v5, v7, vcc
    v_cndmask_b32 v186, v5, v186, vcc
    s_lshl_b32 s90, s12, 3
    s_add_u32 s90, s90, s10
    s_mul_i32 s90, s90, 6144
    s_lshl_b32 s96, s11, 8
    s_add_u32 s96, s96, 0
    s_waitcnt lgkmcnt(0)
    s_mov_b32 s36, s64
    s_and_b32 s37, s65, 0xffff
    s_mov_b32 s38, 1280
    s_mov_b32 s39, 0x00020000
    s_add_u32 s16, s66, s13
    s_addc_u32 s17, s67, 0
    s_and_b32 s17, s17, 0xffff
    s_mov_b32 s18, 3145728
    s_mov_b32 s19, 0x00020000
    s_add_u32 s20, s68, s13
    s_addc_u32 s21, s69, 0
    s_and_b32 s21, s21, 0xffff
    s_mov_b32 s22, 3145728
    s_mov_b32 s23, 0x00020000
    s_mov_b32 s28, s70
    s_and_b32 s29, s71, 0xffff
    s_mov_b32 s30, 7864320
    s_mov_b32 s31, 0x00020000
    s_mov_b32 s32, s76
    s_and_b32 s33, s77, 0xffff
    s_mov_b32 s34, 1966080
    s_mov_b32 s35, 0x00020000
    s_mov_b32 s24, s88
    s_and_b32 s25, s89, 0xffff
    s_mov_b32 s26, 402653184
    s_mov_b32 s27, 0x00020000
    s_mov_b32 s60, s86
    s_and_b32 s61, s87, 0xffff
    s_mov_b32 s62, 256
    s_mov_b32 s63, 0x00020000
    v_lshlrev_b32 v5, 2, v1
    buffer_load_dword v26, v5, s[36:39], 0 offen offset:0
    buffer_load_dword v27, v5, s[36:39], 0 offen offset:256
    buffer_load_dword v28, v5, s[36:39], 0 offen offset:512
    buffer_load_dword v29, v5, s[36:39], 0 offen offset:768
    buffer_load_dword v30, v5, s[36:39], 0 offen offset:1024
    s_cmp_lg_u32 s10, 0
    s_cbranch_scc1 L_init_done
    v_mov_b32 v154, 0
    v_lshlrev_b32 v155, 6, v1
    s_cmp_lg_u32 s12, 0
    s_cbranch_scc1 L_init_cg
    v_cmp_eq_u32 vcc, 0, v1
    v_mov_b32 v157, 0x1000
    s_nop 0
    v_cndmask_b32 v157, v154, v157, vcc
    v_cmp_gt_u32 vcc, 3, v1
    s_and_saveexec_b64 s[92:93], vcc
    buffer_store_dword v157, v155, s[24:27], s96 offen sc1
    s_mov_b64 exec, -1
    v_mov_b32 v228, -1
    v_mov_b32 v229, -1
    v_mov_b32 v230, -1
    v_mov_b32 v231, -1
    s_lshl_b32 s14, s11, 13
    s_add_u32 s14, s14, 491520
    buffer_store_dwordx4 v[228:231], v185, s[24:27], s14 offen offset:0 sc1
    buffer_store_dwordx4 v[228:231], v185, s[24:27], s14 offen offset:1024 sc1
    buffer_store_dwordx4 v[228:231], v185, s[24:27], s14 offen offset:2048 sc1
    buffer_store_dwordx4 v[228:231], v185, s[24:27], s14 offen offset:3072 sc1
    s_add_u32 s14, s14, 4096
    buffer_store_dwordx4 v[228:231], v185, s[24:27], s14 offen offset:0 sc1
    buffer_store_dwordx4 v[228:231], v185, s[24:27], s14 offen offset:1024 sc1
    buffer_store_dwordx4 v[228:231], v185, s[24:27], s14 offen offset:2048 sc1
    buffer_store_dwordx4 v[228:231], v185, s[24:27], s14 offen offset:3072 sc1
    s_waitcnt vmcnt(0)
    s_lshl_b32 s14, s11, 2
    v_mov_b32 v155, s14
    v_mov_b32 v156, 1
    v_cmp_eq_u32 vcc, 0, v1
    s_and_saveexec_b64 s[92:93], vcc
    buffer_atomic_add v156, v155, s[60:63], 0 offen
    s_mov_b64 exec, -1
L_init_cg:
    s_cmp_lg_u32 s11, 0
    s_cbranch_scc1 L_init_done
    s_lshl_b32 s14, s12, 8
    s_add_u32 s14, s14, 8192
    v_cmp_eq_u32 vcc, 0, v1
    s_and_saveexec_b64 s[92:93], vcc
    buffer_store_dword v154, off, s[24:27], s14 sc1
    s_waitcnt vmcnt(0)
    s_lshl_b32 s14, s12, 2
    s_add_u32 s14, s14, 128
    v_mov_b32 v155, s14
    v_mov_b32 v156, 1
    buffer_atomic_add v156, v155, s[60:63], 0 offen
    s_mov_b64 exec, -1
L_init_done:
    s_mul_i32 s14, s11, 384
    s_mul_i32 s15, s12, 983040
    s_add_u32 s14, s14, s15
    s_mul_i32 s95, s11, 96
    s_mul_i32 s15, s12, 245760
    s_add_u32 s15, s95, s15
    buffer_load_dwordx4 v[188:191], v7, s[28:31], s14 offen
    s_add_u32 s14, s14, 245760
    buffer_load_dwordx4 v[192:195], v7, s[28:31], s14 offen
    s_add_u32 s14, s14, 245760
    buffer_load_dwordx4 v[196:199], v7, s[28:31], s14 offen
    s_add_u32 s14, s14, 245760
    buffer_load_dwordx4 v[200:203], v7, s[28:31], s14 offen
    buffer_load_dwordx4 v[204:207], v186, s[32:35], s15 offen
    s_add_u32 s91, s90, 393216
    s_add_u32 s99, s90, 786432
    s_mul_i32 s94, s10, 12288
    s_add_u32 s98, s94, 37376
    s_mov_b32 s40, s72
    s_and_b32 s41, s73, 0xffff
    s_mov_b32 s42, 7864320
    s_mov_b32 s43, 0x00020000
    s_mov_b32 s48, s78
    s_and_b32 s49, s79, 0xffff
    s_mov_b32 s50, 3072
    s_mov_b32 s51, 0x00020000
    s_mov_b32 s44, s80
    s_and_b32 s45, s81, 0xffff
    s_mov_b32 s46, 1966080
    s_mov_b32 s47, 0x00020000
    s_mov_b32 s52, s82
    s_and_b32 s53, s83, 0xffff
    s_mov_b32 s54, 1280
    s_mov_b32 s55, 0x00020000
    s_mov_b32 s56, s84
    s_and_b32 s57, s85, 0xffff
    s_mov_b32 s58, 1280
    s_mov_b32 s59, 0x00020000
    s_cmp_eq_u32 s10, 0
    s_cbranch_scc1 L_noearly
    buffer_load_dwordx4 v[32:35], v2, s[16:19], s90 offen offset:0 sc1 nt
    buffer_load_dwordx4 v[36:39], v2, s[16:19], s90 offen offset:64 sc1 nt
    buffer_load_dwordx4 v[40:43], v2, s[16:19], s90 offen offset:128 sc1 nt
    buffer_load_dwordx4 v[44:47], v2, s[16:19], s90 offen offset:192 sc1 nt
    buffer_load_dwordx4 v[48:51], v2, s[16:19], s90 offen offset:256 sc1 nt
    buffer_load_dwordx4 v[52:55], v2, s[16:19], s90 offen offset:320 sc1 nt
    buffer_load_dwordx4 v[56:59], v4, s[20:23], s90 offen offset:0 sc1 nt
    buffer_load_dwordx4 v[60:63], v4, s[20:23], s90 offen offset:768 sc1 nt
    buffer_load_dwordx4 v[64:67], v4, s[20:23], s90 offen offset:1536 sc1 nt
    buffer_load_dwordx4 v[68:71], v4, s[20:23], s90 offen offset:2304 sc1 nt
    buffer_load_dwordx4 v[72:75], v6, s[20:23], s90 offen offset:0 sc1 nt
    buffer_load_dwordx4 v[76:79], v6, s[20:23], s90 offen offset:768 sc1 nt
    buffer_load_dwordx4 v[80:83], v6, s[20:23], s90 offen offset:1536 sc1 nt
    buffer_load_dwordx4 v[84:87], v6, s[20:23], s90 offen offset:2304 sc1 nt
    s_waitcnt vmcnt(19)
    s_branch L_early_done
L_noearly:
    s_waitcnt vmcnt(5)
L_early_done:
    v_lshlrev_b32 v8, 16, v26
    v_and_b32 v9, 0xffff0000, v26
    v_lshlrev_b32 v10, 16, v27
    v_and_b32 v11, 0xffff0000, v27
    v_lshlrev_b32 v12, 16, v28
    v_and_b32 v13, 0xffff0000, v28
    v_lshlrev_b32 v14, 16, v29
    v_and_b32 v15, 0xffff0000, v29
    v_lshlrev_b32 v16, 16, v30
    v_and_b32 v17, 0xffff0000, v30
    v_add_f32 v20, v8, v9
    v_add_f32 v20, v20, v10
    v_add_f32 v20, v20, v11
    v_add_f32 v20, v20, v12
    v_add_f32 v20, v20, v13
    v_add_f32 v20, v20, v14
    v_add_f32 v20, v20, v15
    v_add_f32 v20, v20, v16
    v_add_f32 v20, v20, v17
    s_nop 1
    v_add_f32_dpp v20, v20, v20 row_shr:1 row_mask:0xf bank_mask:0xf bound_ctrl:0
    s_nop 1
    v_add_f32_dpp v20, v20, v20 row_shr:2 row_mask:0xf bank_mask:0xf bound_ctrl:0
    s_nop 1
    v_add_f32_dpp v20, v20, v20 row_shr:4 row_mask:0xf bank_mask:0xf bound_ctrl:0
    s_nop 1
    v_add_f32_dpp v20, v20, v20 row_shr:8 row_mask:0xf bank_mask:0xf bound_ctrl:0
    s_nop 1
    v_add_f32_dpp v20, v20, v20 row_bcast:15 row_mask:0xa bank_mask:0xf
    s_nop 1
    v_add_f32_dpp v20, v20, v20 row_bcast:31 row_mask:0xc bank_mask:0xf
    s_nop 1
    v_readlane_b32 s15, v20, 63
    s_nop 3
    v_mov_b32 v21, s15
    v_mul_f32 v21, 0x3acccccd, v21
    v_mov_b32 v20, 0
    v_sub_f32 v22, v8, v21
    v_fmac_f32 v20, v22, v22
    v_sub_f32 v22, v9, v21
    v_fmac_f32 v20, v22, v22
    v_sub_f32 v22, v10, v21
    v_fmac_f32 v20, v22, v22
    v_sub_f32 v22, v11, v21
    v_fmac_f32 v20, v22, v22
    v_sub_f32 v22, v12, v21
    v_fmac_f32 v20, v22, v22
    v_sub_f32 v22, v13, v21
    v_fmac_f32 v20, v22, v22
    v_sub_f32 v22, v14, v21
    v_fmac_f32 v20, v22, v22
    v_sub_f32 v22, v15, v21
    v_fmac_f32 v20, v22, v22
    v_sub_f32 v22, v16, v21
    v_fmac_f32 v20, v22, v22
    v_sub_f32 v22, v17, v21
    v_fmac_f32 v20, v22, v22
    s_nop 1
    v_add_f32_dpp v20, v20, v20 row_shr:1 row_mask:0xf bank_mask:0xf bound_ctrl:0
    s_nop 1
    v_add_f32_dpp v20, v20, v20 row_shr:2 row_mask:0xf bank_mask:0xf bound_ctrl:0
    s_nop 1
    v_add_f32_dpp v20, v20, v20 row_shr:4 row_mask:0xf bank_mask:0xf bound_ctrl:0
    s_nop 1
    v_add_f32_dpp v20, v20, v20 row_shr:8 row_mask:0xf bank_mask:0xf bound_ctrl:0
    s_nop 1
    v_add_f32_dpp v20, v20, v20 row_bcast:15 row_mask:0xa bank_mask:0xf
    s_nop 1
    v_add_f32_dpp v20, v20, v20 row_bcast:31 row_mask:0xc bank_mask:0xf
    s_nop 1
    v_readlane_b32 s15, v20, 63
    s_nop 3
    v_mov_b32 v20, s15
    v_mul_f32 v20, 0x3acccccd, v20
    v_cvt_pk_bf16_f32 v20, v20, v20
    v_lshlrev_b32 v20, 16, v20
    v_cvt_pk_bf16_f32 v21, v21, v21
    v_lshlrev_b32 v21, 16, v21
    v_add_f32 v20, 0x3727c5ac, v20
    v_cvt_pk_bf16_f32 v20, v20, v20
    v_lshlrev_b32 v20, 16, v20
    v_sqrt_f32 v20, v20
    s_nop 1
    v_cvt_pk_bf16_f32 v20, v20, v20
    v_lshlrev_b32 v20, 16, v20
    v_rcp_f32 v22, v20
    s_nop 1
    v_fma_f32 v20, -v20, v22, 1.0
    v_fmac_f32 v22, v20, v22
    v_sub_f32 v8, v8, v21
    v_cvt_pk_bf16_f32 v8, v8, v8
    v_lshlrev_b32 v8, 16, v8
    v_mul_f32 v8, v8, v22
    v_cvt_pk_bf16_f32 v8, v8, v8
    v_lshlrev_b32 v8, 16, v8
    v_sub_f32 v9, v9, v21
    v_cvt_pk_bf16_f32 v9, v9, v9
    v_lshlrev_b32 v9, 16, v9
    v_mul_f32 v9, v9, v22
    v_cvt_pk_bf16_f32 v9, v9, v9
    v_lshlrev_b32 v9, 16, v9
    v_sub_f32 v10, v10, v21
    v_cvt_pk_bf16_f32 v10, v10, v10
    v_lshlrev_b32 v10, 16, v10
    v_mul_f32 v10, v10, v22
    v_cvt_pk_bf16_f32 v10, v10, v10
    v_lshlrev_b32 v10, 16, v10
    v_sub_f32 v11, v11, v21
    v_cvt_pk_bf16_f32 v11, v11, v11
    v_lshlrev_b32 v11, 16, v11
    v_mul_f32 v11, v11, v22
    v_cvt_pk_bf16_f32 v11, v11, v11
    v_lshlrev_b32 v11, 16, v11
    v_sub_f32 v12, v12, v21
    v_cvt_pk_bf16_f32 v12, v12, v12
    v_lshlrev_b32 v12, 16, v12
    v_mul_f32 v12, v12, v22
    v_cvt_pk_bf16_f32 v12, v12, v12
    v_lshlrev_b32 v12, 16, v12
    v_sub_f32 v13, v13, v21
    v_cvt_pk_bf16_f32 v13, v13, v13
    v_lshlrev_b32 v13, 16, v13
    v_mul_f32 v13, v13, v22
    v_cvt_pk_bf16_f32 v13, v13, v13
    v_lshlrev_b32 v13, 16, v13
    v_sub_f32 v14, v14, v21
    v_cvt_pk_bf16_f32 v14, v14, v14
    v_lshlrev_b32 v14, 16, v14
    v_mul_f32 v14, v14, v22
    v_cvt_pk_bf16_f32 v14, v14, v14
    v_lshlrev_b32 v14, 16, v14
    v_sub_f32 v15, v15, v21
    v_cvt_pk_bf16_f32 v15, v15, v15
    v_lshlrev_b32 v15, 16, v15
    v_mul_f32 v15, v15, v22
    v_cvt_pk_bf16_f32 v15, v15, v15
    v_lshlrev_b32 v15, 16, v15
    v_sub_f32 v16, v16, v21
    v_cvt_pk_bf16_f32 v16, v16, v16
    v_lshlrev_b32 v16, 16, v16
    v_mul_f32 v16, v16, v22
    v_cvt_pk_bf16_f32 v16, v16, v16
    v_lshlrev_b32 v16, 16, v16
    v_sub_f32 v17, v17, v21
    v_cvt_pk_bf16_f32 v17, v17, v17
    v_lshlrev_b32 v17, 16, v17
    v_mul_f32 v17, v17, v22
    v_cvt_pk_bf16_f32 v17, v17, v17
    v_lshlrev_b32 v17, 16, v17
    v_lshlrev_b32 v5, 3, v1
    ds_write_b64 v5, v[8:9] offset:0
    ds_write_b64 v5, v[10:11] offset:512
    ds_write_b64 v5, v[12:13] offset:1024
    ds_write_b64 v5, v[14:15] offset:1536
    ds_write_b64 v5, v[16:17] offset:2048
    v_add_f32 v20, v8, v9
    v_add_f32 v20, v20, v10
    v_add_f32 v20, v20, v11
    v_add_f32 v20, v20, v12
    v_add_f32 v20, v20, v13
    v_add_f32 v20, v20, v14
    v_add_f32 v20, v20, v15
    v_add_f32 v20, v20, v16
    v_add_f32 v20, v20, v17
    s_nop 1
    v_add_f32_dpp v20, v20, v20 row_shr:1 row_mask:0xf bank_mask:0xf bound_ctrl:0
    s_nop 1
    v_add_f32_dpp v20, v20, v20 row_shr:2 row_mask:0xf bank_mask:0xf bound_ctrl:0
    s_nop 1
    v_add_f32_dpp v20, v20, v20 row_shr:4 row_mask:0xf bank_mask:0xf bound_ctrl:0
    s_nop 1
    v_add_f32_dpp v20, v20, v20 row_shr:8 row_mask:0xf bank_mask:0xf bound_ctrl:0
    s_nop 1
    v_add_f32_dpp v20, v20, v20 row_bcast:15 row_mask:0xa bank_mask:0xf
    s_nop 1
    v_add_f32_dpp v20, v20, v20 row_bcast:31 row_mask:0xc bank_mask:0xf
    s_nop 1
    v_readlane_b32 s15, v20, 63
    s_nop 3
    v_mov_b32 v21, s15
    v_mul_f32 v21, 0x3acccccd, v21
    v_mov_b32 v20, 0
    v_sub_f32 v22, v8, v21
    v_fmac_f32 v20, v22, v22
    v_sub_f32 v22, v9, v21
    v_fmac_f32 v20, v22, v22
    v_sub_f32 v22, v10, v21
    v_fmac_f32 v20, v22, v22
    v_sub_f32 v22, v11, v21
    v_fmac_f32 v20, v22, v22
    v_sub_f32 v22, v12, v21
    v_fmac_f32 v20, v22, v22
    v_sub_f32 v22, v13, v21
    v_fmac_f32 v20, v22, v22
    v_sub_f32 v22, v14, v21
    v_fmac_f32 v20, v22, v22
    v_sub_f32 v22, v15, v21
    v_fmac_f32 v20, v22, v22
    v_sub_f32 v22, v16, v21
    v_fmac_f32 v20, v22, v22
    v_sub_f32 v22, v17, v21
    v_fmac_f32 v20, v22, v22
    s_nop 1
    v_add_f32_dpp v20, v20, v20 row_shr:1 row_mask:0xf bank_mask:0xf bound_ctrl:0
    s_nop 1
    v_add_f32_dpp v20, v20, v20 row_shr:2 row_mask:0xf bank_mask:0xf bound_ctrl:0
    s_nop 1
    v_add_f32_dpp v20, v20, v20 row_shr:4 row_mask:0xf bank_mask:0xf bound_ctrl:0
    s_nop 1
    v_add_f32_dpp v20, v20, v20 row_shr:8 row_mask:0xf bank_mask:0xf bound_ctrl:0
    s_nop 1
    v_add_f32_dpp v20, v20, v20 row_bcast:15 row_mask:0xa bank_mask:0xf
    s_nop 1
    v_add_f32_dpp v20, v20, v20 row_bcast:31 row_mask:0xc bank_mask:0xf
    s_nop 1
    v_readlane_b32 s15, v20, 63
    s_nop 3
    v_mov_b32 v20, s15
    v_mul_f32 v20, 0x3acccccd, v20
    v_cvt_pk_bf16_f32 v20, v20, v20
    v_lshlrev_b32 v20, 16, v20
    v_cvt_pk_bf16_f32 v21, v21, v21
    v_lshlrev_b32 v21, 16, v21
    v_add_f32 v20, 0x3727c5ac, v20
    v_cvt_pk_bf16_f32 v20, v20, v20
    v_lshlrev_b32 v20, 16, v20
    v_sqrt_f32 v20, v20
    s_nop 1
    v_cvt_pk_bf16_f32 v20, v20, v20
    v_lshlrev_b32 v20, 16, v20
    v_rcp_f32 v22, v20
    s_nop 1
    v_fma_f32 v20, -v20, v22, 1.0
    v_fmac_f32 v22, v20, v22
    v_sub_f32 v8, v8, v21
    v_cvt_pk_bf16_f32 v8, v8, v8
    v_lshlrev_b32 v8, 16, v8
    v_mul_f32 v8, v8, v22
    v_cvt_pk_bf16_f32 v8, v8, v8
    v_lshlrev_b32 v8, 16, v8
    v_sub_f32 v9, v9, v21
    v_cvt_pk_bf16_f32 v9, v9, v9
    v_lshlrev_b32 v9, 16, v9
    v_mul_f32 v9, v9, v22
    v_cvt_pk_bf16_f32 v9, v9, v9
    v_lshlrev_b32 v9, 16, v9
    v_sub_f32 v10, v10, v21
    v_cvt_pk_bf16_f32 v10, v10, v10
    v_lshlrev_b32 v10, 16, v10
    v_mul_f32 v10, v10, v22
    v_cvt_pk_bf16_f32 v10, v10, v10
    v_lshlrev_b32 v10, 16, v10
    v_sub_f32 v11, v11, v21
    v_cvt_pk_bf16_f32 v11, v11, v11
    v_lshlrev_b32 v11, 16, v11
    v_mul_f32 v11, v11, v22
    v_cvt_pk_bf16_f32 v11, v11, v11
    v_lshlrev_b32 v11, 16, v11
    v_sub_f32 v12, v12, v21
    v_cvt_pk_bf16_f32 v12, v12, v12
    v_lshlrev_b32 v12, 16, v12
    v_mul_f32 v12, v12, v22
    v_cvt_pk_bf16_f32 v12, v12, v12
    v_lshlrev_b32 v12, 16, v12
    v_sub_f32 v13, v13, v21
    v_cvt_pk_bf16_f32 v13, v13, v13
    v_lshlrev_b32 v13, 16, v13
    v_mul_f32 v13, v13, v22
    v_cvt_pk_bf16_f32 v13, v13, v13
    v_lshlrev_b32 v13, 16, v13
    v_sub_f32 v14, v14, v21
    v_cvt_pk_bf16_f32 v14, v14, v14
    v_lshlrev_b32 v14, 16, v14
    v_mul_f32 v14, v14, v22
    v_cvt_pk_bf16_f32 v14, v14, v14
    v_lshlrev_b32 v14, 16, v14
    v_sub_f32 v15, v15, v21
    v_cvt_pk_bf16_f32 v15, v15, v15
    v_lshlrev_b32 v15, 16, v15
    v_mul_f32 v15, v15, v22
    v_cvt_pk_bf16_f32 v15, v15, v15
    v_lshlrev_b32 v15, 16, v15
    v_sub_f32 v16, v16, v21
    v_cvt_pk_bf16_f32 v16, v16, v16
    v_lshlrev_b32 v16, 16, v16
    v_mul_f32 v16, v16, v22
    v_cvt_pk_bf16_f32 v16, v16, v16
    v_lshlrev_b32 v16, 16, v16
    v_sub_f32 v17, v17, v21
    v_cvt_pk_bf16_f32 v17, v17, v17
    v_lshlrev_b32 v17, 16, v17
    v_mul_f32 v17, v17, v22
    v_cvt_pk_bf16_f32 v17, v17, v17
    v_lshlrev_b32 v17, 16, v17
    ds_write_b64 v5, v[8:9] offset:2560
    ds_write_b64 v5, v[10:11] offset:3072
    ds_write_b64 v5, v[12:13] offset:3584
    ds_write_b64 v5, v[14:15] offset:4096
    ds_write_b64 v5, v[16:17] offset:4608
    s_waitcnt lgkmcnt(0)
    s_barrier
    v_mov_b32 v144, 0
    v_mov_b32 v145, 0
    v_mov_b32 v146, 0
    v_mov_b32 v147, 0
    v_mov_b32 v148, 0
    v_mov_b32 v149, 0
    v_mov_b32 v150, 0
    v_mov_b32 v151, 0
    s_mul_i32 s15, s12, 320
    v_lshlrev_b32 v5, 2, v180
    v_add_u32 v5, s15, v5
    v_add_u32 v154, s15, v187
    ds_read_b32 v160, v5 offset:0
    ds_read_b32 v161, v5 offset:80
    ds_read_b32 v162, v5 offset:160
    ds_read_b32 v163, v5 offset:240
    ds_read_b32 v164, v154 offset:2560
    s_waitcnt vmcnt(14) lgkmcnt(0)
    s_cmp_lg_u32 s10, 0
    s_cbranch_scc1 L_e2
    s_waitcnt vmcnt(0)
L_e2:
    v_lshlrev_b32 v154, 16, v188
    v_and_b32 v155, 0xffff0000, v188
    v_fmac_f32 v144, v154, v160
    v_fmac_f32 v145, v155, v160
    v_lshlrev_b32 v154, 16, v189
    v_and_b32 v155, 0xffff0000, v189
    v_fmac_f32 v146, v154, v160
    v_fmac_f32 v147, v155, v160
    v_lshlrev_b32 v154, 16, v190
    v_and_b32 v155, 0xffff0000, v190
    v_fmac_f32 v148, v154, v160
    v_fmac_f32 v149, v155, v160
    v_lshlrev_b32 v154, 16, v191
    v_and_b32 v155, 0xffff0000, v191
    v_fmac_f32 v150, v154, v160
    v_fmac_f32 v151, v155, v160
    v_lshlrev_b32 v154, 16, v192
    v_and_b32 v155, 0xffff0000, v192
    v_fmac_f32 v144, v154, v161
    v_fmac_f32 v145, v155, v161
    v_lshlrev_b32 v154, 16, v193
    v_and_b32 v155, 0xffff0000, v193
    v_fmac_f32 v146, v154, v161
    v_fmac_f32 v147, v155, v161
    v_lshlrev_b32 v154, 16, v194
    v_and_b32 v155, 0xffff0000, v194
    v_fmac_f32 v148, v154, v161
    v_fmac_f32 v149, v155, v161
    v_lshlrev_b32 v154, 16, v195
    v_and_b32 v155, 0xffff0000, v195
    v_fmac_f32 v150, v154, v161
    v_fmac_f32 v151, v155, v161
    v_lshlrev_b32 v154, 16, v196
    v_and_b32 v155, 0xffff0000, v196
    v_fmac_f32 v144, v154, v162
    v_fmac_f32 v145, v155, v162
    v_lshlrev_b32 v154, 16, v197
    v_and_b32 v155, 0xffff0000, v197
    v_fmac_f32 v146, v154, v162
    v_fmac_f32 v147, v155, v162
    v_lshlrev_b32 v154, 16, v198
    v_and_b32 v155, 0xffff0000, v198
    v_fmac_f32 v148, v154, v162
    v_fmac_f32 v149, v155, v162
    v_lshlrev_b32 v154, 16, v199
    v_and_b32 v155, 0xffff0000, v199
    v_fmac_f32 v150, v154, v162
    v_fmac_f32 v151, v155, v162
    v_lshlrev_b32 v154, 16, v200
    v_and_b32 v155, 0xffff0000, v200
    v_fmac_f32 v144, v154, v163
    v_fmac_f32 v145, v155, v163
    v_lshlrev_b32 v154, 16, v201
    v_and_b32 v155, 0xffff0000, v201
    v_fmac_f32 v146, v154, v163
    v_fmac_f32 v147, v155, v163
    v_lshlrev_b32 v154, 16, v202
    v_and_b32 v155, 0xffff0000, v202
    v_fmac_f32 v148, v154, v163
    v_fmac_f32 v149, v155, v163
    v_lshlrev_b32 v154, 16, v203
    v_and_b32 v155, 0xffff0000, v203
    v_fmac_f32 v150, v154, v163
    v_fmac_f32 v151, v155, v163
    v_mul_u32_u24 v154, 768, v180
    v_lshlrev_b32 v155, 5, v181
    v_add_u32 v154, v154, v155
    v_cmp_gt_u32 vcc, 480, v0
    s_and_saveexec_b64 s[92:93], vcc
    ds_write_b128 v154, v[144:147] offset:5120
    ds_write_b128 v154, v[148:151] offset:5136
    s_or_b64 exec, exec, s[92:93]
    v_lshlrev_b32 v154, 16, v204
    v_and_b32 v155, 0xffff0000, v204
    v_mul_f32 v144, v154, v164
    v_mul_f32 v145, v155, v164
    v_lshlrev_b32 v154, 16, v205
    v_and_b32 v155, 0xffff0000, v205
    v_mul_f32 v146, v154, v164
    v_mul_f32 v147, v155, v164
    v_lshlrev_b32 v154, 16, v206
    v_and_b32 v155, 0xffff0000, v206
    v_mul_f32 v148, v154, v164
    v_mul_f32 v149, v155, v164
    v_lshlrev_b32 v154, 16, v207
    v_and_b32 v155, 0xffff0000, v207
    v_mul_f32 v150, v154, v164
    v_mul_f32 v151, v155, v164
    v_mul_u32_u24 v154, 48, v187
    v_lshlrev_b32 v155, 5, v171
    v_add_u32 v154, v154, v155
    v_cmp_gt_u32 vcc, 480, v0
    s_and_saveexec_b64 s[92:93], vcc
    ds_write_b128 v154, v[144:147] offset:20480
    ds_write_b128 v154, v[148:151] offset:20496
    s_or_b64 exec, exec, s[92:93]
    s_waitcnt lgkmcnt(0)
    s_barrier
    s_cmp_eq_u32 s10, 0
    s_cbranch_scc1 L_chain
    buffer_load_dwordx4 v[88:91], v2, s[16:19], s91 offen offset:0 sc1 nt
    buffer_load_dwordx4 v[92:95], v2, s[16:19], s91 offen offset:64 sc1 nt
    buffer_load_dwordx4 v[96:99], v2, s[16:19], s91 offen offset:128 sc1 nt
    buffer_load_dwordx4 v[100:103], v2, s[16:19], s91 offen offset:192 sc1 nt
    buffer_load_dwordx4 v[104:107], v2, s[16:19], s91 offen offset:256 sc1 nt
    buffer_load_dwordx4 v[108:111], v2, s[16:19], s91 offen offset:320 sc1 nt
    buffer_load_dwordx4 v[112:115], v4, s[20:23], s91 offen offset:0 sc1 nt
    buffer_load_dwordx4 v[116:119], v4, s[20:23], s91 offen offset:768 sc1 nt
    buffer_load_dwordx4 v[120:123], v4, s[20:23], s91 offen offset:1536 sc1 nt
    buffer_load_dwordx4 v[124:127], v4, s[20:23], s91 offen offset:2304 sc1 nt
    buffer_load_dwordx4 v[128:131], v6, s[20:23], s91 offen offset:0 sc1 nt
    buffer_load_dwordx4 v[132:135], v6, s[20:23], s91 offen offset:768 sc1 nt
    buffer_load_dwordx4 v[136:139], v6, s[20:23], s91 offen offset:1536 sc1 nt
    buffer_load_dwordx4 v[140:143], v6, s[20:23], s91 offen offset:2304 sc1 nt
    s_add_u32 s94, s98, 0
    s_mov_b32 m0, s94
    s_add_u32 s94, s99, 0
    buffer_load_dwordx4 v185, s[16:19], s94 offen offset:0 sc1 nt lds
    buffer_load_dwordx4 v185, s[16:19], s94 offen offset:1024 sc1 nt lds
    buffer_load_dwordx4 v185, s[16:19], s94 offen offset:2048 sc1 nt lds
    s_add_u32 s94, s98, 3072
    s_mov_b32 m0, s94
    s_add_u32 s94, s99, 3072
    buffer_load_dwordx4 v185, s[16:19], s94 offen offset:0 sc1 nt lds
    buffer_load_dwordx4 v185, s[16:19], s94 offen offset:1024 sc1 nt lds
    buffer_load_dwordx4 v185, s[16:19], s94 offen offset:2048 sc1 nt lds
    s_add_u32 s94, s98, 6144
    s_mov_b32 m0, s94
    s_add_u32 s94, s99, 0
    buffer_load_dwordx4 v185, s[20:23], s94 offen offset:0 sc1 nt lds
    buffer_load_dwordx4 v185, s[20:23], s94 offen offset:1024 sc1 nt lds
    buffer_load_dwordx4 v185, s[20:23], s94 offen offset:2048 sc1 nt lds
    s_add_u32 s94, s98, 9216
    s_mov_b32 m0, s94
    s_add_u32 s94, s99, 3072
    buffer_load_dwordx4 v185, s[20:23], s94 offen offset:0 sc1 nt lds
    buffer_load_dwordx4 v185, s[20:23], s94 offen offset:1024 sc1 nt lds
    buffer_load_dwordx4 v185, s[20:23], s94 offen offset:2048 sc1 nt lds
    s_branch L_chain_done
L_chain:
    s_lshl_b32 s15, s11, 2
    v_mov_b32 v234, s15
    s_lshl_b32 s15, s12, 2
    s_add_u32 s15, s15, 128
    v_mov_b32 v235, s15
    v_lshlrev_b32 v155, 4, v1
    v_cmp_gt_u32 vcc, 48, v1
    s_and_saveexec_b64 s[92:93], vcc
    ds_read_b128 v[208:211], v155 offset:5120
    ds_read_b128 v[212:215], v155 offset:5888
    ds_read_b128 v[216:219], v155 offset:6656
    ds_read_b128 v[220:223], v155 offset:7424
    ds_read_b128 v[224:227], v155 offset:8192
    s_waitcnt lgkmcnt(0)
    v_mov_b32 v144, v208
    v_mov_b32 v145, v209
    v_mov_b32 v146, v210
    v_mov_b32 v147, v211
    v_add_f32 v144, v144, v212
    v_add_f32 v145, v145, v213
    v_add_f32 v146, v146, v214
    v_add_f32 v147, v147, v215
    v_add_f32 v144, v144, v216
    v_add_f32 v145, v145, v217
    v_add_f32 v146, v146, v218
    v_add_f32 v147, v147, v219
    v_add_f32 v144, v144, v220
    v_add_f32 v145, v145, v221
    v_add_f32 v146, v146, v222
    v_add_f32 v147, v147, v223
    v_add_f32 v144, v144, v224
    v_add_f32 v145, v145, v225
    v_add_f32 v146, v146, v226
    v_add_f32 v147, v147, v227
    ds_read_b128 v[208:211], v155 offset:8960
    ds_read_b128 v[212:215], v155 offset:9728
    ds_read_b128 v[216:219], v155 offset:10496
    ds_read_b128 v[220:223], v155 offset:11264
    ds_read_b128 v[224:227], v155 offset:12032
    s_waitcnt lgkmcnt(0)
    v_add_f32 v144, v144, v208
    v_add_f32 v145, v145, v209
    v_add_f32 v146, v146, v210
    v_add_f32 v147, v147, v211
    v_add_f32 v144, v144, v212
    v_add_f32 v145, v145, v213
    v_add_f32 v146, v146, v214
    v_add_f32 v147, v147, v215
    v_add_f32 v144, v144, v216
    v_add_f32 v145, v145, v217
    v_add_f32 v146, v146, v218
    v_add_f32 v147, v147, v219
    v_add_f32 v144, v144, v220
    v_add_f32 v145, v145, v221
    v_add_f32 v146, v146, v222
    v_add_f32 v147, v147, v223
    v_add_f32 v144, v144, v224
    v_add_f32 v145, v145, v225
    v_add_f32 v146, v146, v226
    v_add_f32 v147, v147, v227
    ds_read_b128 v[208:211], v155 offset:12800
    ds_read_b128 v[212:215], v155 offset:13568
    ds_read_b128 v[216:219], v155 offset:14336
    ds_read_b128 v[220:223], v155 offset:15104
    ds_read_b128 v[224:227], v155 offset:15872
    s_waitcnt lgkmcnt(0)
    v_add_f32 v144, v144, v208
    v_add_f32 v145, v145, v209
    v_add_f32 v146, v146, v210
    v_add_f32 v147, v147, v211
    v_add_f32 v144, v144, v212
    v_add_f32 v145, v145, v213
    v_add_f32 v146, v146, v214
    v_add_f32 v147, v147, v215
    v_add_f32 v144, v144, v216
    v_add_f32 v145, v145, v217
    v_add_f32 v146, v146, v218
    v_add_f32 v147, v147, v219
    v_add_f32 v144, v144, v220
    v_add_f32 v145, v145, v221
    v_add_f32 v146, v146, v222
    v_add_f32 v147, v147, v223
    v_add_f32 v144, v144, v224
    v_add_f32 v145, v145, v225
    v_add_f32 v146, v146, v226
    v_add_f32 v147, v147, v227
    ds_read_b128 v[208:211], v155 offset:16640
    ds_read_b128 v[212:215], v155 offset:17408
    ds_read_b128 v[216:219], v155 offset:18176
    ds_read_b128 v[220:223], v155 offset:18944
    ds_read_b128 v[224:227], v155 offset:19712
    s_waitcnt lgkmcnt(0)
    v_add_f32 v144, v144, v208
    v_add_f32 v145, v145, v209
    v_add_f32 v146, v146, v210
    v_add_f32 v147, v147, v211
    v_add_f32 v144, v144, v212
    v_add_f32 v145, v145, v213
    v_add_f32 v146, v146, v214
    v_add_f32 v147, v147, v215
    v_add_f32 v144, v144, v216
    v_add_f32 v145, v145, v217
    v_add_f32 v146, v146, v218
    v_add_f32 v147, v147, v219
    v_add_f32 v144, v144, v220
    v_add_f32 v145, v145, v221
    v_add_f32 v146, v146, v222
    v_add_f32 v147, v147, v223
    v_add_f32 v144, v144, v224
    v_add_f32 v145, v145, v225
    v_add_f32 v146, v146, v226
    v_add_f32 v147, v147, v227
    s_mov_b64 exec, -1
    v_cmp_le_u32 vcc, 48, v1
    s_and_saveexec_b64 s[92:93], vcc
    v_cmp_gt_u32 vcc, 60, v1
    s_and_b64 exec, exec, vcc
    ds_read_b128 v[208:211], v155 offset:19712
    ds_read_b128 v[212:215], v155 offset:19904
    ds_read_b128 v[216:219], v155 offset:20096
    ds_read_b128 v[220:223], v155 offset:20288
    ds_read_b128 v[224:227], v155 offset:20480
    s_waitcnt lgkmcnt(0)
    v_mov_b32 v144, v208
    v_mov_b32 v145, v209
    v_mov_b32 v146, v210
    v_mov_b32 v147, v211
    v_add_f32 v144, v144, v212
    v_add_f32 v145, v145, v213
    v_add_f32 v146, v146, v214
    v_add_f32 v147, v147, v215
    v_add_f32 v144, v144, v216
    v_add_f32 v145, v145, v217
    v_add_f32 v146, v146, v218
    v_add_f32 v147, v147, v219
    v_add_f32 v144, v144, v220
    v_add_f32 v145, v145, v221
    v_add_f32 v146, v146, v222
    v_add_f32 v147, v147, v223
    v_add_f32 v144, v144, v224
    v_add_f32 v145, v145, v225
    v_add_f32 v146, v146, v226
    v_add_f32 v147, v147, v227
    ds_read_b128 v[208:211], v155 offset:20672
    ds_read_b128 v[212:215], v155 offset:20864
    ds_read_b128 v[216:219], v155 offset:21056
    ds_read_b128 v[220:223], v155 offset:21248
    ds_read_b128 v[224:227], v155 offset:21440
    s_waitcnt lgkmcnt(0)
    v_add_f32 v144, v144, v208
    v_add_f32 v145, v145, v209
    v_add_f32 v146, v146, v210
    v_add_f32 v147, v147, v211
    v_add_f32 v144, v144, v212
    v_add_f32 v145, v145, v213
    v_add_f32 v146, v146, v214
    v_add_f32 v147, v147, v215
    v_add_f32 v144, v144, v216
    v_add_f32 v145, v145, v217
    v_add_f32 v146, v146, v218
    v_add_f32 v147, v147, v219
    v_add_f32 v144, v144, v220
    v_add_f32 v145, v145, v221
    v_add_f32 v146, v146, v222
    v_add_f32 v147, v147, v223
    v_add_f32 v144, v144, v224
    v_add_f32 v145, v145, v225
    v_add_f32 v146, v146, v226
    v_add_f32 v147, v147, v227
    ds_read_b128 v[208:211], v155 offset:21632
    ds_read_b128 v[212:215], v155 offset:21824
    ds_read_b128 v[216:219], v155 offset:22016
    ds_read_b128 v[220:223], v155 offset:22208
    ds_read_b128 v[224:227], v155 offset:22400
    s_waitcnt lgkmcnt(0)
    v_add_f32 v144, v144, v208
    v_add_f32 v145, v145, v209
    v_add_f32 v146, v146, v210
    v_add_f32 v147, v147, v211
    v_add_f32 v144, v144, v212
    v_add_f32 v145, v145, v213
    v_add_f32 v146, v146, v214
    v_add_f32 v147, v147, v215
    v_add_f32 v144, v144, v216
    v_add_f32 v145, v145, v217
    v_add_f32 v146, v146, v218
    v_add_f32 v147, v147, v219
    v_add_f32 v144, v144, v220
    v_add_f32 v145, v145, v221
    v_add_f32 v146, v146, v222
    v_add_f32 v147, v147, v223
    v_add_f32 v144, v144, v224
    v_add_f32 v145, v145, v225
    v_add_f32 v146, v146, v226
    v_add_f32 v147, v147, v227
    ds_read_b128 v[208:211], v155 offset:22592
    ds_read_b128 v[212:215], v155 offset:22784
    ds_read_b128 v[216:219], v155 offset:22976
    ds_read_b128 v[220:223], v155 offset:23168
    ds_read_b128 v[224:227], v155 offset:23360
    s_waitcnt lgkmcnt(0)
    v_add_f32 v144, v144, v208
    v_add_f32 v145, v145, v209
    v_add_f32 v146, v146, v210
    v_add_f32 v147, v147, v211
    v_add_f32 v144, v144, v212
    v_add_f32 v145, v145, v213
    v_add_f32 v146, v146, v214
    v_add_f32 v147, v147, v215
    v_add_f32 v144, v144, v216
    v_add_f32 v145, v145, v217
    v_add_f32 v146, v146, v218
    v_add_f32 v147, v147, v219
    v_add_f32 v144, v144, v220
    v_add_f32 v145, v145, v221
    v_add_f32 v146, v146, v222
    v_add_f32 v147, v147, v223
    v_add_f32 v144, v144, v224
    v_add_f32 v145, v145, v225
    v_add_f32 v146, v146, v226
    v_add_f32 v147, v147, v227
    ds_read_b128 v[208:211], v155 offset:23552
    ds_read_b128 v[212:215], v155 offset:23744
    ds_read_b128 v[216:219], v155 offset:23936
    ds_read_b128 v[220:223], v155 offset:24128
    ds_read_b128 v[224:227], v155 offset:24320
    s_waitcnt lgkmcnt(0)
    v_add_f32 v144, v144, v208
    v_add_f32 v145, v145, v209
    v_add_f32 v146, v146, v210
    v_add_f32 v147, v147, v211
    v_add_f32 v144, v144, v212
    v_add_f32 v145, v145, v213
    v_add_f32 v146, v146, v214
    v_add_f32 v147, v147, v215
    v_add_f32 v144, v144, v216
    v_add_f32 v145, v145, v217
    v_add_f32 v146, v146, v218
    v_add_f32 v147, v147, v219
    v_add_f32 v144, v144, v220
    v_add_f32 v145, v145, v221
    v_add_f32 v146, v146, v222
    v_add_f32 v147, v147, v223
    v_add_f32 v144, v144, v224
    v_add_f32 v145, v145, v225
    v_add_f32 v146, v146, v226
    v_add_f32 v147, v147, v227
    ds_read_b128 v[208:211], v155 offset:24512
    ds_read_b128 v[212:215], v155 offset:24704
    ds_read_b128 v[216:219], v155 offset:24896
    ds_read_b128 v[220:223], v155 offset:25088
    ds_read_b128 v[224:227], v155 offset:25280
    s_waitcnt lgkmcnt(0)
    v_add_f32 v144, v144, v208
    v_add_f32 v145, v145, v209
    v_add_f32 v146, v146, v210
    v_add_f32 v147, v147, v211
    v_add_f32 v144, v144, v212
    v_add_f32 v145, v145, v213
    v_add_f32 v146, v146, v214
    v_add_f32 v147, v147, v215
    v_add_f32 v144, v144, v216
    v_add_f32 v145, v145, v217
    v_add_f32 v146, v146, v218
    v_add_f32 v147, v147, v219
    v_add_f32 v144, v144, v220
    v_add_f32 v145, v145, v221
    v_add_f32 v146, v146, v222
    v_add_f32 v147, v147, v223
    v_add_f32 v144, v144, v224
    v_add_f32 v145, v145, v225
    v_add_f32 v146, v146, v226
    v_add_f32 v147, v147, v227
    ds_read_b128 v[208:211], v155 offset:25472
    ds_read_b128 v[212:215], v155 offset:25664
    ds_read_b128 v[216:219], v155 offset:25856
    ds_read_b128 v[220:223], v155 offset:26048
    ds_read_b128 v[224:227], v155 offset:26240
    s_waitcnt lgkmcnt(0)
    v_add_f32 v144, v144, v208
    v_add_f32 v145, v145, v209
    v_add_f32 v146, v146, v210
    v_add_f32 v147, v147, v211
    v_add_f32 v144, v144, v212
    v_add_f32 v145, v145, v213
    v_add_f32 v146, v146, v214
    v_add_f32 v147, v147, v215
    v_add_f32 v144, v144, v216
    v_add_f32 v145, v145, v217
    v_add_f32 v146, v146, v218
    v_add_f32 v147, v147, v219
    v_add_f32 v144, v144, v220
    v_add_f32 v145, v145, v221
    v_add_f32 v146, v146, v222
    v_add_f32 v147, v147, v223
    v_add_f32 v144, v144, v224
    v_add_f32 v145, v145, v225
    v_add_f32 v146, v146, v226
    v_add_f32 v147, v147, v227
    ds_read_b128 v[208:211], v155 offset:26432
    ds_read_b128 v[212:215], v155 offset:26624
    ds_read_b128 v[216:219], v155 offset:26816
    ds_read_b128 v[220:223], v155 offset:27008
    ds_read_b128 v[224:227], v155 offset:27200
    s_waitcnt lgkmcnt(0)
    v_add_f32 v144, v144, v208
    v_add_f32 v145, v145, v209
    v_add_f32 v146, v146, v210
    v_add_f32 v147, v147, v211
    v_add_f32 v144, v144, v212
    v_add_f32 v145, v145, v213
    v_add_f32 v146, v146, v214
    v_add_f32 v147, v147, v215
    v_add_f32 v144, v144, v216
    v_add_f32 v145, v145, v217
    v_add_f32 v146, v146, v218
    v_add_f32 v147, v147, v219
    v_add_f32 v144, v144, v220
    v_add_f32 v145, v145, v221
    v_add_f32 v146, v146, v222
    v_add_f32 v147, v147, v223
    v_add_f32 v144, v144, v224
    v_add_f32 v145, v145, v225
    v_add_f32 v146, v146, v226
    v_add_f32 v147, v147, v227
    ds_read_b128 v[208:211], v155 offset:27392
    ds_read_b128 v[212:215], v155 offset:27584
    ds_read_b128 v[216:219], v155 offset:27776
    ds_read_b128 v[220:223], v155 offset:27968
    ds_read_b128 v[224:227], v155 offset:28160
    s_waitcnt lgkmcnt(0)
    v_add_f32 v144, v144, v208
    v_add_f32 v145, v145, v209
    v_add_f32 v146, v146, v210
    v_add_f32 v147, v147, v211
    v_add_f32 v144, v144, v212
    v_add_f32 v145, v145, v213
    v_add_f32 v146, v146, v214
    v_add_f32 v147, v147, v215
    v_add_f32 v144, v144, v216
    v_add_f32 v145, v145, v217
    v_add_f32 v146, v146, v218
    v_add_f32 v147, v147, v219
    v_add_f32 v144, v144, v220
    v_add_f32 v145, v145, v221
    v_add_f32 v146, v146, v222
    v_add_f32 v147, v147, v223
    v_add_f32 v144, v144, v224
    v_add_f32 v145, v145, v225
    v_add_f32 v146, v146, v226
    v_add_f32 v147, v147, v227
    ds_read_b128 v[208:211], v155 offset:28352
    ds_read_b128 v[212:215], v155 offset:28544
    ds_read_b128 v[216:219], v155 offset:28736
    ds_read_b128 v[220:223], v155 offset:28928
    ds_read_b128 v[224:227], v155 offset:29120
    s_waitcnt lgkmcnt(0)
    v_add_f32 v144, v144, v208
    v_add_f32 v145, v145, v209
    v_add_f32 v146, v146, v210
    v_add_f32 v147, v147, v211
    v_add_f32 v144, v144, v212
    v_add_f32 v145, v145, v213
    v_add_f32 v146, v146, v214
    v_add_f32 v147, v147, v215
    v_add_f32 v144, v144, v216
    v_add_f32 v145, v145, v217
    v_add_f32 v146, v146, v218
    v_add_f32 v147, v147, v219
    v_add_f32 v144, v144, v220
    v_add_f32 v145, v145, v221
    v_add_f32 v146, v146, v222
    v_add_f32 v147, v147, v223
    v_add_f32 v144, v144, v224
    v_add_f32 v145, v145, v225
    v_add_f32 v146, v146, v226
    v_add_f32 v147, v147, v227
    ds_read_b128 v[208:211], v155 offset:29312
    ds_read_b128 v[212:215], v155 offset:29504
    ds_read_b128 v[216:219], v155 offset:29696
    ds_read_b128 v[220:223], v155 offset:29888
    ds_read_b128 v[224:227], v155 offset:30080
    s_waitcnt lgkmcnt(0)
    v_add_f32 v144, v144, v208
    v_add_f32 v145, v145, v209
    v_add_f32 v146, v146, v210
    v_add_f32 v147, v147, v211
    v_add_f32 v144, v144, v212
    v_add_f32 v145, v145, v213
    v_add_f32 v146, v146, v214
    v_add_f32 v147, v147, v215
    v_add_f32 v144, v144, v216
    v_add_f32 v145, v145, v217
    v_add_f32 v146, v146, v218
    v_add_f32 v147, v147, v219
    v_add_f32 v144, v144, v220
    v_add_f32 v145, v145, v221
    v_add_f32 v146, v146, v222
    v_add_f32 v147, v147, v223
    v_add_f32 v144, v144, v224
    v_add_f32 v145, v145, v225
    v_add_f32 v146, v146, v226
    v_add_f32 v147, v147, v227
    ds_read_b128 v[208:211], v155 offset:30272
    ds_read_b128 v[212:215], v155 offset:30464
    ds_read_b128 v[216:219], v155 offset:30656
    ds_read_b128 v[220:223], v155 offset:30848
    ds_read_b128 v[224:227], v155 offset:31040
    s_waitcnt lgkmcnt(0)
    v_add_f32 v144, v144, v208
    v_add_f32 v145, v145, v209
    v_add_f32 v146, v146, v210
    v_add_f32 v147, v147, v211
    v_add_f32 v144, v144, v212
    v_add_f32 v145, v145, v213
    v_add_f32 v146, v146, v214
    v_add_f32 v147, v147, v215
    v_add_f32 v144, v144, v216
    v_add_f32 v145, v145, v217
    v_add_f32 v146, v146, v218
    v_add_f32 v147, v147, v219
    v_add_f32 v144, v144, v220
    v_add_f32 v145, v145, v221
    v_add_f32 v146, v146, v222
    v_add_f32 v147, v147, v223
    v_add_f32 v144, v144, v224
    v_add_f32 v145, v145, v225
    v_add_f32 v146, v146, v226
    v_add_f32 v147, v147, v227
    ds_read_b128 v[208:211], v155 offset:31232
    ds_read_b128 v[212:215], v155 offset:31424
    ds_read_b128 v[216:219], v155 offset:31616
    ds_read_b128 v[220:223], v155 offset:31808
    ds_read_b128 v[224:227], v155 offset:32000
    s_waitcnt lgkmcnt(0)
    v_add_f32 v144, v144, v208
    v_add_f32 v145, v145, v209
    v_add_f32 v146, v146, v210
    v_add_f32 v147, v147, v211
    v_add_f32 v144, v144, v212
    v_add_f32 v145, v145, v213
    v_add_f32 v146, v146, v214
    v_add_f32 v147, v147, v215
    v_add_f32 v144, v144, v216
    v_add_f32 v145, v145, v217
    v_add_f32 v146, v146, v218
    v_add_f32 v147, v147, v219
    v_add_f32 v144, v144, v220
    v_add_f32 v145, v145, v221
    v_add_f32 v146, v146, v222
    v_add_f32 v147, v147, v223
    v_add_f32 v144, v144, v224
    v_add_f32 v145, v145, v225
    v_add_f32 v146, v146, v226
    v_add_f32 v147, v147, v227
    ds_read_b128 v[208:211], v155 offset:32192
    ds_read_b128 v[212:215], v155 offset:32384
    ds_read_b128 v[216:219], v155 offset:32576
    ds_read_b128 v[220:223], v155 offset:32768
    ds_read_b128 v[224:227], v155 offset:32960
    s_waitcnt lgkmcnt(0)
    v_add_f32 v144, v144, v208
    v_add_f32 v145, v145, v209
    v_add_f32 v146, v146, v210
    v_add_f32 v147, v147, v211
    v_add_f32 v144, v144, v212
    v_add_f32 v145, v145, v213
    v_add_f32 v146, v146, v214
    v_add_f32 v147, v147, v215
    v_add_f32 v144, v144, v216
    v_add_f32 v145, v145, v217
    v_add_f32 v146, v146, v218
    v_add_f32 v147, v147, v219
    v_add_f32 v144, v144, v220
    v_add_f32 v145, v145, v221
    v_add_f32 v146, v146, v222
    v_add_f32 v147, v147, v223
    v_add_f32 v144, v144, v224
    v_add_f32 v145, v145, v225
    v_add_f32 v146, v146, v226
    v_add_f32 v147, v147, v227
    ds_read_b128 v[208:211], v155 offset:33152
    ds_read_b128 v[212:215], v155 offset:33344
    ds_read_b128 v[216:219], v155 offset:33536
    ds_read_b128 v[220:223], v155 offset:33728
    ds_read_b128 v[224:227], v155 offset:33920
    s_waitcnt lgkmcnt(0)
    v_add_f32 v144, v144, v208
    v_add_f32 v145, v145, v209
    v_add_f32 v146, v146, v210
    v_add_f32 v147, v147, v211
    v_add_f32 v144, v144, v212
    v_add_f32 v145, v145, v213
    v_add_f32 v146, v146, v214
    v_add_f32 v147, v147, v215
    v_add_f32 v144, v144, v216
    v_add_f32 v145, v145, v217
    v_add_f32 v146, v146, v218
    v_add_f32 v147, v147, v219
    v_add_f32 v144, v144, v220
    v_add_f32 v145, v145, v221
    v_add_f32 v146, v146, v222
    v_add_f32 v147, v147, v223
    v_add_f32 v144, v144, v224
    v_add_f32 v145, v145, v225
    v_add_f32 v146, v146, v226
    v_add_f32 v147, v147, v227
    ds_read_b128 v[208:211], v155 offset:34112
    ds_read_b128 v[212:215], v155 offset:34304
    ds_read_b128 v[216:219], v155 offset:34496
    ds_read_b128 v[220:223], v155 offset:34688
    ds_read_b128 v[224:227], v155 offset:34880
    s_waitcnt lgkmcnt(0)
    v_add_f32 v144, v144, v208
    v_add_f32 v145, v145, v209
    v_add_f32 v146, v146, v210
    v_add_f32 v147, v147, v211
    v_add_f32 v144, v144, v212
    v_add_f32 v145, v145, v213
    v_add_f32 v146, v146, v214
    v_add_f32 v147, v147, v215
    v_add_f32 v144, v144, v216
    v_add_f32 v145, v145, v217
    v_add_f32 v146, v146, v218
    v_add_f32 v147, v147, v219
    v_add_f32 v144, v144, v220
    v_add_f32 v145, v145, v221
    v_add_f32 v146, v146, v222
    v_add_f32 v147, v147, v223
    v_add_f32 v144, v144, v224
    v_add_f32 v145, v145, v225
    v_add_f32 v146, v146, v226
    v_add_f32 v147, v147, v227
    s_mov_b64 exec, -1
    v_mov_b32 v224, -1
    v_mov_b32 v225, -1
    v_mov_b32 v226, -1
    v_mov_b32 v227, -1
    s_lshl_b32 s14, s2, 10
    s_add_u32 s14, s14, 65536
    v_cmp_gt_u32 vcc, 49, v1
    s_and_saveexec_b64 s[92:93], vcc
    buffer_store_dwordx4 v[224:227], v155, s[24:27], s14 offen sc1
    s_mov_b64 exec, -1
    s_mul_i32 s14, s12, 20480
    s_mul_i32 s15, s11, 640
    s_add_u32 s14, s14, s15
    s_add_u32 s14, s14, 327680
    v_cmp_gt_u32 vcc, 40, v1
    s_and_saveexec_b64 s[92:93], vcc
    buffer_store_dwordx4 v[224:227], v155, s[24:27], s14 offen sc1
    s_mov_b64 exec, -1
    s_mov_b32 s94, 0
L_flag:
    buffer_load_dword v232, v234, s[60:63], 0 offen sc1
    buffer_load_dword v233, v235, s[60:63], 0 offen sc1
    s_waitcnt vmcnt(0)
    v_min_u32 v232, v232, v233
    s_nop 0
    v_readfirstlane_b32 s15, v232
    s_nop 3
    s_cmp_lg_u32 s15, 0
    s_cbranch_scc1 L_flag_ok
    s_sleep 8
    s_add_u32 s94, s94, 1
    s_cmp_lt_u32 s94, 0x100000
    s_cbranch_scc1 L_flag
L_flag_ok:
    v_cmp_gt_u32 vcc, 60, v1
    s_and_saveexec_b64 s[92:93], vcc
    s_lshl_b32 s14, s2, 10
    s_add_u32 s14, s14, 491520
    buffer_store_dwordx4 v[144:147], v155, s[24:27], s14 offen sc1
    s_mov_b64 exec, -1
    v_subrev_u32 v228, 48, v1
    v_lshlrev_b32 v228, 3, v228
    buffer_load_dwordx2 v[230:231], v228, s[48:51], s95 offen
    v_cmp_gt_u32 vcc, 60, v1
    s_and_saveexec_b64 s[92:93], vcc
    s_lshl_b32 s15, s11, 13
    s_add_u32 s15, s15, 491520
    s_mov_b32 s94, 0
L_qpoll:
    s_mov_b32 s14, s15
    buffer_load_dwordx4 v[56:59], v155, s[24:27], s14 offen offset:0 sc1
    buffer_load_dwordx4 v[60:63], v155, s[24:27], s14 offen offset:1024 sc1
    buffer_load_dwordx4 v[64:67], v155, s[24:27], s14 offen offset:2048 sc1
    buffer_load_dwordx4 v[68:71], v155, s[24:27], s14 offen offset:3072 sc1
    s_add_u32 s14, s14, 4096
    buffer_load_dwordx4 v[72:75], v155, s[24:27], s14 offen offset:0 sc1
    buffer_load_dwordx4 v[76:79], v155, s[24:27], s14 offen offset:1024 sc1
    buffer_load_dwordx4 v[80:83], v155, s[24:27], s14 offen offset:2048 sc1
    buffer_load_dwordx4 v[84:87], v155, s[24:27], s14 offen offset:3072 sc1
    s_waitcnt vmcnt(0)
    v_max_u32 v232, v56, v57
    v_max_u32 v232, v232, v58
    v_max_u32 v232, v232, v59
    v_max_u32 v232, v232, v60
    v_max_u32 v232, v232, v61
    v_max_u32 v232, v232, v62
    v_max_u32 v232, v232, v63
    v_max_u32 v232, v232, v64
    v_max_u32 v232, v232, v65
    v_max_u32 v232, v232, v66
    v_max_u32 v232, v232, v67
    v_max_u32 v232, v232, v68
    v_max_u32 v232, v232, v69
    v_max_u32 v232, v232, v70
    v_max_u32 v232, v232, v71
    v_max_u32 v232, v232, v72
    v_max_u32 v232, v232, v73
    v_max_u32 v232, v232, v74
    v_max_u32 v232, v232, v75
    v_max_u32 v232, v232, v76
    v_max_u32 v232, v232, v77
    v_max_u32 v232, v232, v78
    v_max_u32 v232, v232, v79
    v_max_u32 v232, v232, v80
    v_max_u32 v232, v232, v81
    v_max_u32 v232, v232, v82
    v_max_u32 v232, v232, v83
    v_max_u32 v232, v232, v84
    v_max_u32 v232, v232, v85
    v_max_u32 v232, v232, v86
    v_max_u32 v232, v232, v87
    v_cmp_eq_u32 vcc, -1, v232
    s_cbranch_vccz L_qpoll_done
    s_sleep 2
    s_add_u32 s94, s94, 1
    s_cmp_lt_u32 s94, 0x100000
    s_cbranch_scc1 L_qpoll
L_qpoll_done:
    v_mov_b32 v144, v56
    v_add_f32 v144, v144, v60
    v_add_f32 v144, v144, v64
    v_add_f32 v144, v144, v68
    v_add_f32 v144, v144, v72
    v_add_f32 v144, v144, v76
    v_add_f32 v144, v144, v80
    v_add_f32 v144, v144, v84
    v_mov_b32 v145, v57
    v_add_f32 v145, v145, v61
    v_add_f32 v145, v145, v65
    v_add_f32 v145, v145, v69
    v_add_f32 v145, v145, v73
    v_add_f32 v145, v145, v77
    v_add_f32 v145, v145, v81
    v_add_f32 v145, v145, v85
    v_mov_b32 v146, v58
    v_add_f32 v146, v146, v62
    v_add_f32 v146, v146, v66
    v_add_f32 v146, v146, v70
    v_add_f32 v146, v146, v74
    v_add_f32 v146, v146, v78
    v_add_f32 v146, v146, v82
    v_add_f32 v146, v146, v86
    v_mov_b32 v147, v59
    v_add_f32 v147, v147, v63
    v_add_f32 v147, v147, v67
    v_add_f32 v147, v147, v71
    v_add_f32 v147, v147, v75
    v_add_f32 v147, v147, v79
    v_add_f32 v147, v147, v83
    v_add_f32 v147, v147, v87
    v_cvt_pk_bf16_f32 v208, v144, v145
    v_cvt_pk_bf16_f32 v209, v146, v147
    v_lshlrev_b32 v210, 3, v1
    v_cmp_gt_u32 vcc, 48, v1
    s_and_saveexec_b64 s[100:101], vcc
    ds_write_b64 v210, v[208:209] offset:35840
    s_mov_b64 exec, s[100:101]
    v_lshlrev_b32 v144, 16, v208
    v_and_b32 v145, 0xffff0000, v208
    v_lshlrev_b32 v146, 16, v209
    v_and_b32 v147, 0xffff0000, v209
    v_lshlrev_b32 v212, 16, v230
    v_and_b32 v213, 0xffff0000, v230
    v_lshlrev_b32 v214, 16, v231
    v_and_b32 v215, 0xffff0000, v231
    v_add_f32 v144, v144, v212
    v_cvt_pk_bf16_f32 v144, v144, v144
    v_lshlrev_b32 v144, 16, v144
    v_mul_f32 v216, v144, v144
    v_mul_f32 v216, 0x3d372713, v216
    v_add_f32 v216, 1.0, v216
    v_mul_f32 v216, v216, v144
    v_mul_f32 v216, 0xc0135761, v216
    v_exp_f32 v216, v216
    s_nop 1
    v_add_f32 v216, 1.0, v216
    v_rcp_f32 v216, v216
    s_nop 1
    v_mul_f32 v144, v144, v216
    v_cvt_pk_bf16_f32 v144, v144, v144
    v_lshlrev_b32 v144, 16, v144
    v_add_f32 v145, v145, v213
    v_cvt_pk_bf16_f32 v145, v145, v145
    v_lshlrev_b32 v145, 16, v145
    v_mul_f32 v217, v145, v145
    v_mul_f32 v217, 0x3d372713, v217
    v_add_f32 v217, 1.0, v217
    v_mul_f32 v217, v217, v145
    v_mul_f32 v217, 0xc0135761, v217
    v_exp_f32 v217, v217
    s_nop 1
    v_add_f32 v217, 1.0, v217
    v_rcp_f32 v217, v217
    s_nop 1
    v_mul_f32 v145, v145, v217
    v_cvt_pk_bf16_f32 v145, v145, v145
    v_lshlrev_b32 v145, 16, v145
    v_add_f32 v146, v146, v214
    v_cvt_pk_bf16_f32 v146, v146, v146
    v_lshlrev_b32 v146, 16, v146
    v_mul_f32 v218, v146, v146
    v_mul_f32 v218, 0x3d372713, v218
    v_add_f32 v218, 1.0, v218
    v_mul_f32 v218, v218, v146
    v_mul_f32 v218, 0xc0135761, v218
    v_exp_f32 v218, v218
    s_nop 1
    v_add_f32 v218, 1.0, v218
    v_rcp_f32 v218, v218
    s_nop 1
    v_mul_f32 v146, v146, v218
    v_cvt_pk_bf16_f32 v146, v146, v146
    v_lshlrev_b32 v146, 16, v146
    v_add_f32 v147, v147, v215
    v_cvt_pk_bf16_f32 v147, v147, v147
    v_lshlrev_b32 v147, 16, v147
    v_mul_f32 v219, v147, v147
    v_mul_f32 v219, 0x3d372713, v219
    v_add_f32 v219, 1.0, v219
    v_mul_f32 v219, v219, v147
    v_mul_f32 v219, 0xc0135761, v219
    v_exp_f32 v219, v219
    s_nop 1
    v_add_f32 v219, 1.0, v219
    v_rcp_f32 v219, v219
    s_nop 1
    v_mul_f32 v147, v147, v219
    v_cvt_pk_bf16_f32 v147, v147, v147
    v_lshlrev_b32 v147, 16, v147
    v_cmp_le_u32 vcc, 48, v1
    s_and_b64 exec, exec, vcc
    v_lshlrev_b32 v228, 1, v228
    ds_write_b128 v228, v[144:147] offset:36224
    s_mov_b64 exec, -1
    s_waitcnt lgkmcnt(0)
    s_barrier
    buffer_load_dwordx4 v[32:35], v2, s[16:19], s90 offen offset:0 sc1 nt
    buffer_load_dwordx4 v[36:39], v2, s[16:19], s90 offen offset:64 sc1 nt
    buffer_load_dwordx4 v[40:43], v2, s[16:19], s90 offen offset:128 sc1 nt
    buffer_load_dwordx4 v[44:47], v2, s[16:19], s90 offen offset:192 sc1 nt
    buffer_load_dwordx4 v[48:51], v2, s[16:19], s90 offen offset:256 sc1 nt
    buffer_load_dwordx4 v[52:55], v2, s[16:19], s90 offen offset:320 sc1 nt
    buffer_load_dwordx4 v[56:59], v4, s[20:23], s90 offen offset:0 sc1 nt
    buffer_load_dwordx4 v[60:63], v4, s[20:23], s90 offen offset:768 sc1 nt
    buffer_load_dwordx4 v[64:67], v4, s[20:23], s90 offen offset:1536 sc1 nt
    buffer_load_dwordx4 v[68:71], v4, s[20:23], s90 offen offset:2304 sc1 nt
    buffer_load_dwordx4 v[72:75], v6, s[20:23], s90 offen offset:0 sc1 nt
    buffer_load_dwordx4 v[76:79], v6, s[20:23], s90 offen offset:768 sc1 nt
    buffer_load_dwordx4 v[80:83], v6, s[20:23], s90 offen offset:1536 sc1 nt
    buffer_load_dwordx4 v[84:87], v6, s[20:23], s90 offen offset:2304 sc1 nt
    buffer_load_dwordx4 v[88:91], v2, s[16:19], s91 offen offset:0 sc1 nt
    buffer_load_dwordx4 v[92:95], v2, s[16:19], s91 offen offset:64 sc1 nt
    buffer_load_dwordx4 v[96:99], v2, s[16:19], s91 offen offset:128 sc1 nt
    buffer_load_dwordx4 v[100:103], v2, s[16:19], s91 offen offset:192 sc1 nt
    buffer_load_dwordx4 v[104:107], v2, s[16:19], s91 offen offset:256 sc1 nt
    buffer_load_dwordx4 v[108:111], v2, s[16:19], s91 offen offset:320 sc1 nt
    buffer_load_dwordx4 v[112:115], v4, s[20:23], s91 offen offset:0 sc1 nt
    buffer_load_dwordx4 v[116:119], v4, s[20:23], s91 offen offset:768 sc1 nt
    buffer_load_dwordx4 v[120:123], v4, s[20:23], s91 offen offset:1536 sc1 nt
    buffer_load_dwordx4 v[124:127], v4, s[20:23], s91 offen offset:2304 sc1 nt
    buffer_load_dwordx4 v[128:131], v6, s[20:23], s91 offen offset:0 sc1 nt
    buffer_load_dwordx4 v[132:135], v6, s[20:23], s91 offen offset:768 sc1 nt
    buffer_load_dwordx4 v[136:139], v6, s[20:23], s91 offen offset:1536 sc1 nt
    buffer_load_dwordx4 v[140:143], v6, s[20:23], s91 offen offset:2304 sc1 nt
    s_add_u32 s94, s98, 0
    s_mov_b32 m0, s94
    s_add_u32 s94, s99, 0
    buffer_load_dwordx4 v185, s[16:19], s94 offen offset:0 sc1 nt lds
    buffer_load_dwordx4 v185, s[16:19], s94 offen offset:1024 sc1 nt lds
    buffer_load_dwordx4 v185, s[16:19], s94 offen offset:2048 sc1 nt lds
    s_add_u32 s94, s98, 3072
    s_mov_b32 m0, s94
    s_add_u32 s94, s99, 3072
    buffer_load_dwordx4 v185, s[16:19], s94 offen offset:0 sc1 nt lds
    buffer_load_dwordx4 v185, s[16:19], s94 offen offset:1024 sc1 nt lds
    buffer_load_dwordx4 v185, s[16:19], s94 offen offset:2048 sc1 nt lds
    s_add_u32 s94, s98, 6144
    s_mov_b32 m0, s94
    s_add_u32 s94, s99, 0
    buffer_load_dwordx4 v185, s[20:23], s94 offen offset:0 sc1 nt lds
    buffer_load_dwordx4 v185, s[20:23], s94 offen offset:1024 sc1 nt lds
    buffer_load_dwordx4 v185, s[20:23], s94 offen offset:2048 sc1 nt lds
    s_add_u32 s94, s98, 9216
    s_mov_b32 m0, s94
    s_add_u32 s94, s99, 3072
    buffer_load_dwordx4 v185, s[20:23], s94 offen offset:0 sc1 nt lds
    buffer_load_dwordx4 v185, s[20:23], s94 offen offset:1024 sc1 nt lds
    buffer_load_dwordx4 v185, s[20:23], s94 offen offset:2048 sc1 nt lds
    s_branch L_chain_done2
L_chain_done:
    s_barrier
L_chain_done2:
    ds_read_b128 v[8:11], v3 offset:35840
    ds_read_b128 v[12:15], v3 offset:35904
    ds_read_b128 v[16:19], v3 offset:35968
    ds_read_b128 v[20:23], v3 offset:36032
    ds_read_b128 v[24:27], v3 offset:36096
    ds_read_b128 v[28:31], v3 offset:36160
    v_mov_b32 v182, 1
    v_mov_b32 v183, 1
    v_cmp_eq_u32 vcc, 0, v1
    s_and_saveexec_b64 s[92:93], vcc
    buffer_atomic_add v183, off, s[24:27], s96 sc0
    buffer_atomic_add v182, off, s[24:27], s96 sc0
    s_or_b64 exec, exec, s[92:93]
    s_waitcnt lgkmcnt(0)
    v_cmp_le_u32 vcc, 24, v1
    v_mov_b32 v5, 0
    v_mov_b32 v154, 4
    s_nop 1
    v_cndmask_b32 v5, v5, v154, vcc
    v_add_u32 v172, 0, v5
    v_mov_b32 v144, 0
    v_add_u32 v173, 8, v5
    v_mov_b32 v145, 0
    v_add_u32 v174, 16, v5
    v_mov_b32 v146, 0
    v_add_u32 v175, 24, v5
    v_mov_b32 v147, 0
    v_add_u32 v176, 32, v5
    v_mov_b32 v148, 0
    v_add_u32 v177, 40, v5
    v_mov_b32 v149, 0
    v_add_u32 v178, 48, v5
    v_mov_b32 v150, 0
    v_add_u32 v179, 56, v5
    v_mov_b32 v151, 0
    v_mov_b32 v152, 0xff800000
    v_mov_b32 v153, 0
    v_mul_u32_u24 v154, 205, v0
    v_lshrrev_b32 v180, 11, v154
    v_mul_u32_u24 v154, 10, v180
    v_sub_u32 v181, v0, v154
    v_mul_u32_u24 v7, 1280, v180
    v_lshlrev_b32 v154, 4, v181
    v_add_u32 v7, v7, v154
    v_mov_b32 v154, 0x40000000
    v_cmp_gt_u32 vcc, 480, v0
    s_nop 1
    v_cndmask_b32 v7, v154, v7, vcc
    s_mul_i32 s14, s10, 12288
    s_add_u32 s14, s14, 37376
    v_add_u32 v188, s14, v2
    v_add_u32 v189, s14, v185
    s_waitcnt vmcnt(0)
    v_mfma_f32_16x16x32_bf16 v[168:171], v[8:11], v[32:35], 0
    v_mfma_f32_16x16x32_bf16 v[168:171], v[12:15], v[36:39], v[168:171]
    v_mfma_f32_16x16x32_bf16 v[168:171], v[16:19], v[40:43], v[168:171]
    v_mfma_f32_16x16x32_bf16 v[168:171], v[20:23], v[44:47], v[168:171]
    v_mfma_f32_16x16x32_bf16 v[168:171], v[24:27], v[48:51], v[168:171]
    v_mfma_f32_16x16x32_bf16 v[168:171], v[28:31], v[52:55], v[168:171]
    ds_read_b128 v[32:35], v188 offset:0
    ds_read_b128 v[36:39], v188 offset:64
    ds_read_b128 v[40:43], v188 offset:128
    ds_read_b128 v[44:47], v188 offset:192
    ds_read_b128 v[48:51], v188 offset:256
    ds_read_b128 v[52:55], v188 offset:320
    s_nop 8
    v_cvt_pk_bf16_f32 v154, v168, v168
    v_lshlrev_b32 v154, 16, v154
    v_mul_f32 v154, 0x3d93cd3a, v154
    v_cvt_pk_bf16_f32 v154, v154, v154
    v_lshlrev_b32 v154, 16, v154
    v_mul_f32 v154, 0x3fb8aa3b, v154
    s_nop 1
    v_max_f32_dpp v155, v154, v154 row_ror:8 row_mask:0xf bank_mask:0xf
    s_nop 1
    v_max_f32_dpp v155, v155, v155 row_ror:4 row_mask:0xf bank_mask:0xf
    s_nop 1
    v_max_f32_dpp v155, v155, v155 row_ror:2 row_mask:0xf bank_mask:0xf
    s_nop 1
    v_max_f32_dpp v155, v155, v155 row_ror:1 row_mask:0xf bank_mask:0xf
    v_max_f32 v155, v155, v152
    v_sub_f32 v156, v152, v155
    v_sub_f32 v157, v154, v155
    v_exp_f32 v156, v156
    v_exp_f32 v157, v157
    v_mov_b32 v152, v155
    v_fma_f32 v153, v153, v156, v157
    ds_bpermute_b32 v160, v172, v157
    ds_bpermute_b32 v161, v173, v157
    ds_bpermute_b32 v162, v174, v157
    ds_bpermute_b32 v163, v175, v157
    ds_bpermute_b32 v164, v176, v157
    ds_bpermute_b32 v165, v177, v157
    ds_bpermute_b32 v166, v178, v157
    ds_bpermute_b32 v167, v179, v157
    v_mul_f32 v144, v144, v156
    v_mul_f32 v145, v145, v156
    v_mul_f32 v146, v146, v156
    v_mul_f32 v147, v147, v156
    v_mul_f32 v148, v148, v156
    v_mul_f32 v149, v149, v156
    v_mul_f32 v150, v150, v156
    v_mul_f32 v151, v151, v156
    s_waitcnt lgkmcnt(0)
    v_lshlrev_b32 v158, 16, v56
    v_and_b32 v159, 0xffff0000, v56
    v_fmac_f32 v144, v158, v160
    v_fmac_f32 v145, v159, v160
    v_lshlrev_b32 v158, 16, v57
    v_and_b32 v159, 0xffff0000, v57
    v_fmac_f32 v146, v158, v160
    v_fmac_f32 v147, v159, v160
    v_lshlrev_b32 v158, 16, v58
    v_and_b32 v159, 0xffff0000, v58
    v_fmac_f32 v148, v158, v160
    v_fmac_f32 v149, v159, v160
    v_lshlrev_b32 v158, 16, v59
    v_and_b32 v159, 0xffff0000, v59
    v_fmac_f32 v150, v158, v160
    v_fmac_f32 v151, v159, v160
    v_lshlrev_b32 v158, 16, v60
    v_and_b32 v159, 0xffff0000, v60
    v_fmac_f32 v144, v158, v161
    v_fmac_f32 v145, v159, v161
    v_lshlrev_b32 v158, 16, v61
    v_and_b32 v159, 0xffff0000, v61
    v_fmac_f32 v146, v158, v161
    v_fmac_f32 v147, v159, v161
    v_lshlrev_b32 v158, 16, v62
    v_and_b32 v159, 0xffff0000, v62
    v_fmac_f32 v148, v158, v161
    v_fmac_f32 v149, v159, v161
    v_lshlrev_b32 v158, 16, v63
    v_and_b32 v159, 0xffff0000, v63
    v_fmac_f32 v150, v158, v161
    v_fmac_f32 v151, v159, v161
    v_lshlrev_b32 v158, 16, v64
    v_and_b32 v159, 0xffff0000, v64
    v_fmac_f32 v144, v158, v162
    v_fmac_f32 v145, v159, v162
    v_lshlrev_b32 v158, 16, v65
    v_and_b32 v159, 0xffff0000, v65
    v_fmac_f32 v146, v158, v162
    v_fmac_f32 v147, v159, v162
    v_lshlrev_b32 v158, 16, v66
    v_and_b32 v159, 0xffff0000, v66
    v_fmac_f32 v148, v158, v162
    v_fmac_f32 v149, v159, v162
    v_lshlrev_b32 v158, 16, v67
    v_and_b32 v159, 0xffff0000, v67
    v_fmac_f32 v150, v158, v162
    v_fmac_f32 v151, v159, v162
    v_lshlrev_b32 v158, 16, v68
    v_and_b32 v159, 0xffff0000, v68
    v_fmac_f32 v144, v158, v163
    v_fmac_f32 v145, v159, v163
    v_lshlrev_b32 v158, 16, v69
    v_and_b32 v159, 0xffff0000, v69
    v_fmac_f32 v146, v158, v163
    v_fmac_f32 v147, v159, v163
    v_lshlrev_b32 v158, 16, v70
    v_and_b32 v159, 0xffff0000, v70
    v_fmac_f32 v148, v158, v163
    v_fmac_f32 v149, v159, v163
    v_lshlrev_b32 v158, 16, v71
    v_and_b32 v159, 0xffff0000, v71
    v_fmac_f32 v150, v158, v163
    v_fmac_f32 v151, v159, v163
    v_lshlrev_b32 v158, 16, v72
    v_and_b32 v159, 0xffff0000, v72
    v_fmac_f32 v144, v158, v164
    v_fmac_f32 v145, v159, v164
    v_lshlrev_b32 v158, 16, v73
    v_and_b32 v159, 0xffff0000, v73
    v_fmac_f32 v146, v158, v164
    v_fmac_f32 v147, v159, v164
    v_lshlrev_b32 v158, 16, v74
    v_and_b32 v159, 0xffff0000, v74
    v_fmac_f32 v148, v158, v164
    v_fmac_f32 v149, v159, v164
    v_lshlrev_b32 v158, 16, v75
    v_and_b32 v159, 0xffff0000, v75
    v_fmac_f32 v150, v158, v164
    v_fmac_f32 v151, v159, v164
    v_lshlrev_b32 v158, 16, v76
    v_and_b32 v159, 0xffff0000, v76
    v_fmac_f32 v144, v158, v165
    v_fmac_f32 v145, v159, v165
    v_lshlrev_b32 v158, 16, v77
    v_and_b32 v159, 0xffff0000, v77
    v_fmac_f32 v146, v158, v165
    v_fmac_f32 v147, v159, v165
    v_lshlrev_b32 v158, 16, v78
    v_and_b32 v159, 0xffff0000, v78
    v_fmac_f32 v148, v158, v165
    v_fmac_f32 v149, v159, v165
    v_lshlrev_b32 v158, 16, v79
    v_and_b32 v159, 0xffff0000, v79
    v_fmac_f32 v150, v158, v165
    v_fmac_f32 v151, v159, v165
    v_lshlrev_b32 v158, 16, v80
    v_and_b32 v159, 0xffff0000, v80
    v_fmac_f32 v144, v158, v166
    v_fmac_f32 v145, v159, v166
    v_lshlrev_b32 v158, 16, v81
    v_and_b32 v159, 0xffff0000, v81
    v_fmac_f32 v146, v158, v166
    v_fmac_f32 v147, v159, v166
    v_lshlrev_b32 v158, 16, v82
    v_and_b32 v159, 0xffff0000, v82
    v_fmac_f32 v148, v158, v166
    v_fmac_f32 v149, v159, v166
    v_lshlrev_b32 v158, 16, v83
    v_and_b32 v159, 0xffff0000, v83
    v_fmac_f32 v150, v158, v166
    v_fmac_f32 v151, v159, v166
    v_lshlrev_b32 v158, 16, v84
    v_and_b32 v159, 0xffff0000, v84
    v_fmac_f32 v144, v158, v167
    v_fmac_f32 v145, v159, v167
    v_lshlrev_b32 v158, 16, v85
    v_and_b32 v159, 0xffff0000, v85
    v_fmac_f32 v146, v158, v167
    v_fmac_f32 v147, v159, v167
    v_lshlrev_b32 v158, 16, v86
    v_and_b32 v159, 0xffff0000, v86
    v_fmac_f32 v148, v158, v167
    v_fmac_f32 v149, v159, v167
    v_lshlrev_b32 v158, 16, v87
    v_and_b32 v159, 0xffff0000, v87
    v_fmac_f32 v150, v158, v167
    v_fmac_f32 v151, v159, v167
    ds_read_b128 v[56:59], v189 offset:6144
    ds_read_b128 v[60:63], v189 offset:6912
    ds_read_b128 v[64:67], v189 offset:7680
    ds_read_b128 v[68:71], v189 offset:8448
    ds_read_b128 v[72:75], v189 offset:9216
    ds_read_b128 v[76:79], v189 offset:9984
    ds_read_b128 v[80:83], v189 offset:10752
    ds_read_b128 v[84:87], v189 offset:11520
    v_mfma_f32_16x16x32_bf16 v[168:171], v[8:11], v[88:91], 0
    v_mfma_f32_16x16x32_bf16 v[168:171], v[12:15], v[92:95], v[168:171]
    v_mfma_f32_16x16x32_bf16 v[168:171], v[16:19], v[96:99], v[168:171]
    v_mfma_f32_16x16x32_bf16 v[168:171], v[20:23], v[100:103], v[168:171]
    v_mfma_f32_16x16x32_bf16 v[168:171], v[24:27], v[104:107], v[168:171]
    v_mfma_f32_16x16x32_bf16 v[168:171], v[28:31], v[108:111], v[168:171]
    v_readfirstlane_b32 s91, v183
    s_nop 3
    s_cmp_ge_u32 s91, 0x1000
    s_cbranch_scc1 L_idx0
    s_waitcnt vmcnt(0)
    v_readfirstlane_b32 s91, v183
    s_nop 3
L_idx0:
    s_sub_u32 s91, s91, 3904
    s_mul_i32 s91, s91, 6144
    buffer_load_dwordx4 v[88:91], v2, s[16:19], s91 offen offset:0 sc1 nt
    buffer_load_dwordx4 v[92:95], v2, s[16:19], s91 offen offset:64 sc1 nt
    buffer_load_dwordx4 v[96:99], v2, s[16:19], s91 offen offset:128 sc1 nt
    buffer_load_dwordx4 v[100:103], v2, s[16:19], s91 offen offset:192 sc1 nt
    buffer_load_dwordx4 v[104:107], v2, s[16:19], s91 offen offset:256 sc1 nt
    buffer_load_dwordx4 v[108:111], v2, s[16:19], s91 offen offset:320 sc1 nt
    v_mov_b32 v183, 1
    v_cmp_eq_u32 vcc, 0, v1
    s_and_saveexec_b64 s[92:93], vcc
    buffer_atomic_add v183, off, s[24:27], s96 sc0
    s_or_b64 exec, exec, s[92:93]
    s_nop 8
    v_cvt_pk_bf16_f32 v154, v168, v168
    v_lshlrev_b32 v154, 16, v154
    v_mul_f32 v154, 0x3d93cd3a, v154
    v_cvt_pk_bf16_f32 v154, v154, v154
    v_lshlrev_b32 v154, 16, v154
    v_mul_f32 v154, 0x3fb8aa3b, v154
    s_nop 1
    v_max_f32_dpp v155, v154, v154 row_ror:8 row_mask:0xf bank_mask:0xf
    s_nop 1
    v_max_f32_dpp v155, v155, v155 row_ror:4 row_mask:0xf bank_mask:0xf
    s_nop 1
    v_max_f32_dpp v155, v155, v155 row_ror:2 row_mask:0xf bank_mask:0xf
    s_nop 1
    v_max_f32_dpp v155, v155, v155 row_ror:1 row_mask:0xf bank_mask:0xf
    v_max_f32 v155, v155, v152
    v_sub_f32 v156, v152, v155
    v_sub_f32 v157, v154, v155
    v_exp_f32 v156, v156
    v_exp_f32 v157, v157
    v_mov_b32 v152, v155
    v_fma_f32 v153, v153, v156, v157
    ds_bpermute_b32 v160, v172, v157
    ds_bpermute_b32 v161, v173, v157
    ds_bpermute_b32 v162, v174, v157
    ds_bpermute_b32 v163, v175, v157
    ds_bpermute_b32 v164, v176, v157
    ds_bpermute_b32 v165, v177, v157
    ds_bpermute_b32 v166, v178, v157
    ds_bpermute_b32 v167, v179, v157
    v_mul_f32 v144, v144, v156
    v_mul_f32 v145, v145, v156
    v_mul_f32 v146, v146, v156
    v_mul_f32 v147, v147, v156
    v_mul_f32 v148, v148, v156
    v_mul_f32 v149, v149, v156
    v_mul_f32 v150, v150, v156
    v_mul_f32 v151, v151, v156
    s_waitcnt lgkmcnt(0)
    v_lshlrev_b32 v158, 16, v112
    v_and_b32 v159, 0xffff0000, v112
    v_fmac_f32 v144, v158, v160
    v_fmac_f32 v145, v159, v160
    v_lshlrev_b32 v158, 16, v113
    v_and_b32 v159, 0xffff0000, v113
    v_fmac_f32 v146, v158, v160
    v_fmac_f32 v147, v159, v160
    v_lshlrev_b32 v158, 16, v114
    v_and_b32 v159, 0xffff0000, v114
    v_fmac_f32 v148, v158, v160
    v_fmac_f32 v149, v159, v160
    v_lshlrev_b32 v158, 16, v115
    v_and_b32 v159, 0xffff0000, v115
    v_fmac_f32 v150, v158, v160
    v_fmac_f32 v151, v159, v160
    v_lshlrev_b32 v158, 16, v116
    v_and_b32 v159, 0xffff0000, v116
    v_fmac_f32 v144, v158, v161
    v_fmac_f32 v145, v159, v161
    v_lshlrev_b32 v158, 16, v117
    v_and_b32 v159, 0xffff0000, v117
    v_fmac_f32 v146, v158, v161
    v_fmac_f32 v147, v159, v161
    v_lshlrev_b32 v158, 16, v118
    v_and_b32 v159, 0xffff0000, v118
    v_fmac_f32 v148, v158, v161
    v_fmac_f32 v149, v159, v161
    v_lshlrev_b32 v158, 16, v119
    v_and_b32 v159, 0xffff0000, v119
    v_fmac_f32 v150, v158, v161
    v_fmac_f32 v151, v159, v161
    v_lshlrev_b32 v158, 16, v120
    v_and_b32 v159, 0xffff0000, v120
    v_fmac_f32 v144, v158, v162
    v_fmac_f32 v145, v159, v162
    v_lshlrev_b32 v158, 16, v121
    v_and_b32 v159, 0xffff0000, v121
    v_fmac_f32 v146, v158, v162
    v_fmac_f32 v147, v159, v162
    v_lshlrev_b32 v158, 16, v122
    v_and_b32 v159, 0xffff0000, v122
    v_fmac_f32 v148, v158, v162
    v_fmac_f32 v149, v159, v162
    v_lshlrev_b32 v158, 16, v123
    v_and_b32 v159, 0xffff0000, v123
    v_fmac_f32 v150, v158, v162
    v_fmac_f32 v151, v159, v162
    v_lshlrev_b32 v158, 16, v124
    v_and_b32 v159, 0xffff0000, v124
    v_fmac_f32 v144, v158, v163
    v_fmac_f32 v145, v159, v163
    v_lshlrev_b32 v158, 16, v125
    v_and_b32 v159, 0xffff0000, v125
    v_fmac_f32 v146, v158, v163
    v_fmac_f32 v147, v159, v163
    v_lshlrev_b32 v158, 16, v126
    v_and_b32 v159, 0xffff0000, v126
    v_fmac_f32 v148, v158, v163
    v_fmac_f32 v149, v159, v163
    v_lshlrev_b32 v158, 16, v127
    v_and_b32 v159, 0xffff0000, v127
    v_fmac_f32 v150, v158, v163
    v_fmac_f32 v151, v159, v163
    v_lshlrev_b32 v158, 16, v128
    v_and_b32 v159, 0xffff0000, v128
    v_fmac_f32 v144, v158, v164
    v_fmac_f32 v145, v159, v164
    v_lshlrev_b32 v158, 16, v129
    v_and_b32 v159, 0xffff0000, v129
    v_fmac_f32 v146, v158, v164
    v_fmac_f32 v147, v159, v164
    v_lshlrev_b32 v158, 16, v130
    v_and_b32 v159, 0xffff0000, v130
    v_fmac_f32 v148, v158, v164
    v_fmac_f32 v149, v159, v164
    v_lshlrev_b32 v158, 16, v131
    v_and_b32 v159, 0xffff0000, v131
    v_fmac_f32 v150, v158, v164
    v_fmac_f32 v151, v159, v164
    v_lshlrev_b32 v158, 16, v132
    v_and_b32 v159, 0xffff0000, v132
    v_fmac_f32 v144, v158, v165
    v_fmac_f32 v145, v159, v165
    v_lshlrev_b32 v158, 16, v133
    v_and_b32 v159, 0xffff0000, v133
    v_fmac_f32 v146, v158, v165
    v_fmac_f32 v147, v159, v165
    v_lshlrev_b32 v158, 16, v134
    v_and_b32 v159, 0xffff0000, v134
    v_fmac_f32 v148, v158, v165
    v_fmac_f32 v149, v159, v165
    v_lshlrev_b32 v158, 16, v135
    v_and_b32 v159, 0xffff0000, v135
    v_fmac_f32 v150, v158, v165
    v_fmac_f32 v151, v159, v165
    v_lshlrev_b32 v158, 16, v136
    v_and_b32 v159, 0xffff0000, v136
    v_fmac_f32 v144, v158, v166
    v_fmac_f32 v145, v159, v166
    v_lshlrev_b32 v158, 16, v137
    v_and_b32 v159, 0xffff0000, v137
    v_fmac_f32 v146, v158, v166
    v_fmac_f32 v147, v159, v166
    v_lshlrev_b32 v158, 16, v138
    v_and_b32 v159, 0xffff0000, v138
    v_fmac_f32 v148, v158, v166
    v_fmac_f32 v149, v159, v166
    v_lshlrev_b32 v158, 16, v139
    v_and_b32 v159, 0xffff0000, v139
    v_fmac_f32 v150, v158, v166
    v_fmac_f32 v151, v159, v166
    v_lshlrev_b32 v158, 16, v140
    v_and_b32 v159, 0xffff0000, v140
    v_fmac_f32 v144, v158, v167
    v_fmac_f32 v145, v159, v167
    v_lshlrev_b32 v158, 16, v141
    v_and_b32 v159, 0xffff0000, v141
    v_fmac_f32 v146, v158, v167
    v_fmac_f32 v147, v159, v167
    v_lshlrev_b32 v158, 16, v142
    v_and_b32 v159, 0xffff0000, v142
    v_fmac_f32 v148, v158, v167
    v_fmac_f32 v149, v159, v167
    v_lshlrev_b32 v158, 16, v143
    v_and_b32 v159, 0xffff0000, v143
    v_fmac_f32 v150, v158, v167
    v_fmac_f32 v151, v159, v167
    buffer_load_dwordx4 v[112:115], v4, s[20:23], s91 offen offset:0 sc1 nt
    buffer_load_dwordx4 v[116:119], v4, s[20:23], s91 offen offset:768 sc1 nt
    buffer_load_dwordx4 v[120:123], v4, s[20:23], s91 offen offset:1536 sc1 nt
    buffer_load_dwordx4 v[124:127], v4, s[20:23], s91 offen offset:2304 sc1 nt
    buffer_load_dwordx4 v[128:131], v6, s[20:23], s91 offen offset:0 sc1 nt
    buffer_load_dwordx4 v[132:135], v6, s[20:23], s91 offen offset:768 sc1 nt
    buffer_load_dwordx4 v[136:139], v6, s[20:23], s91 offen offset:1536 sc1 nt
    buffer_load_dwordx4 v[140:143], v6, s[20:23], s91 offen offset:2304 sc1 nt
    s_waitcnt lgkmcnt(0)
    v_mfma_f32_16x16x32_bf16 v[168:171], v[8:11], v[32:35], 0
    v_mfma_f32_16x16x32_bf16 v[168:171], v[12:15], v[36:39], v[168:171]
    v_mfma_f32_16x16x32_bf16 v[168:171], v[16:19], v[40:43], v[168:171]
    v_mfma_f32_16x16x32_bf16 v[168:171], v[20:23], v[44:47], v[168:171]
    v_mfma_f32_16x16x32_bf16 v[168:171], v[24:27], v[48:51], v[168:171]
    v_mfma_f32_16x16x32_bf16 v[168:171], v[28:31], v[52:55], v[168:171]
    v_readfirstlane_b32 s91, v182
    s_nop 3
    s_cmp_ge_u32 s91, 0x1000
    s_cbranch_scc1 L_idx1
    s_waitcnt vmcnt(0)
    v_readfirstlane_b32 s91, v182
    s_nop 3
L_idx1:
    s_sub_u32 s91, s91, 3904
    s_mul_i32 s91, s91, 6144
    buffer_load_dwordx4 v[32:35], v2, s[16:19], s91 offen offset:0 sc1 nt
    buffer_load_dwordx4 v[36:39], v2, s[16:19], s91 offen offset:64 sc1 nt
    buffer_load_dwordx4 v[40:43], v2, s[16:19], s91 offen offset:128 sc1 nt
    buffer_load_dwordx4 v[44:47], v2, s[16:19], s91 offen offset:192 sc1 nt
    buffer_load_dwordx4 v[48:51], v2, s[16:19], s91 offen offset:256 sc1 nt
    buffer_load_dwordx4 v[52:55], v2, s[16:19], s91 offen offset:320 sc1 nt
    v_mov_b32 v182, 1
    v_cmp_eq_u32 vcc, 0, v1
    s_and_saveexec_b64 s[92:93], vcc
    buffer_atomic_add v182, off, s[24:27], s96 sc0
    s_or_b64 exec, exec, s[92:93]
    s_nop 8
    v_cvt_pk_bf16_f32 v154, v168, v168
    v_lshlrev_b32 v154, 16, v154
    v_mul_f32 v154, 0x3d93cd3a, v154
    v_cvt_pk_bf16_f32 v154, v154, v154
    v_lshlrev_b32 v154, 16, v154
    v_mul_f32 v154, 0x3fb8aa3b, v154
    s_nop 1
    v_max_f32_dpp v155, v154, v154 row_ror:8 row_mask:0xf bank_mask:0xf
    s_nop 1
    v_max_f32_dpp v155, v155, v155 row_ror:4 row_mask:0xf bank_mask:0xf
    s_nop 1
    v_max_f32_dpp v155, v155, v155 row_ror:2 row_mask:0xf bank_mask:0xf
    s_nop 1
    v_max_f32_dpp v155, v155, v155 row_ror:1 row_mask:0xf bank_mask:0xf
    v_max_f32 v155, v155, v152
    v_sub_f32 v156, v152, v155
    v_sub_f32 v157, v154, v155
    v_exp_f32 v156, v156
    v_exp_f32 v157, v157
    v_mov_b32 v152, v155
    v_fma_f32 v153, v153, v156, v157
    ds_bpermute_b32 v160, v172, v157
    ds_bpermute_b32 v161, v173, v157
    ds_bpermute_b32 v162, v174, v157
    ds_bpermute_b32 v163, v175, v157
    ds_bpermute_b32 v164, v176, v157
    ds_bpermute_b32 v165, v177, v157
    ds_bpermute_b32 v166, v178, v157
    ds_bpermute_b32 v167, v179, v157
    v_mul_f32 v144, v144, v156
    v_mul_f32 v145, v145, v156
    v_mul_f32 v146, v146, v156
    v_mul_f32 v147, v147, v156
    v_mul_f32 v148, v148, v156
    v_mul_f32 v149, v149, v156
    v_mul_f32 v150, v150, v156
    v_mul_f32 v151, v151, v156
    s_waitcnt lgkmcnt(0)
    v_lshlrev_b32 v158, 16, v56
    v_and_b32 v159, 0xffff0000, v56
    v_fmac_f32 v144, v158, v160
    v_fmac_f32 v145, v159, v160
    v_lshlrev_b32 v158, 16, v57
    v_and_b32 v159, 0xffff0000, v57
    v_fmac_f32 v146, v158, v160
    v_fmac_f32 v147, v159, v160
    v_lshlrev_b32 v158, 16, v58
    v_and_b32 v159, 0xffff0000, v58
    v_fmac_f32 v148, v158, v160
    v_fmac_f32 v149, v159, v160
    v_lshlrev_b32 v158, 16, v59
    v_and_b32 v159, 0xffff0000, v59
    v_fmac_f32 v150, v158, v160
    v_fmac_f32 v151, v159, v160
    v_lshlrev_b32 v158, 16, v60
    v_and_b32 v159, 0xffff0000, v60
    v_fmac_f32 v144, v158, v161
    v_fmac_f32 v145, v159, v161
    v_lshlrev_b32 v158, 16, v61
    v_and_b32 v159, 0xffff0000, v61
    v_fmac_f32 v146, v158, v161
    v_fmac_f32 v147, v159, v161
    v_lshlrev_b32 v158, 16, v62
    v_and_b32 v159, 0xffff0000, v62
    v_fmac_f32 v148, v158, v161
    v_fmac_f32 v149, v159, v161
    v_lshlrev_b32 v158, 16, v63
    v_and_b32 v159, 0xffff0000, v63
    v_fmac_f32 v150, v158, v161
    v_fmac_f32 v151, v159, v161
    v_lshlrev_b32 v158, 16, v64
    v_and_b32 v159, 0xffff0000, v64
    v_fmac_f32 v144, v158, v162
    v_fmac_f32 v145, v159, v162
    v_lshlrev_b32 v158, 16, v65
    v_and_b32 v159, 0xffff0000, v65
    v_fmac_f32 v146, v158, v162
    v_fmac_f32 v147, v159, v162
    v_lshlrev_b32 v158, 16, v66
    v_and_b32 v159, 0xffff0000, v66
    v_fmac_f32 v148, v158, v162
    v_fmac_f32 v149, v159, v162
    v_lshlrev_b32 v158, 16, v67
    v_and_b32 v159, 0xffff0000, v67
    v_fmac_f32 v150, v158, v162
    v_fmac_f32 v151, v159, v162
    v_lshlrev_b32 v158, 16, v68
    v_and_b32 v159, 0xffff0000, v68
    v_fmac_f32 v144, v158, v163
    v_fmac_f32 v145, v159, v163
    v_lshlrev_b32 v158, 16, v69
    v_and_b32 v159, 0xffff0000, v69
    v_fmac_f32 v146, v158, v163
    v_fmac_f32 v147, v159, v163
    v_lshlrev_b32 v158, 16, v70
    v_and_b32 v159, 0xffff0000, v70
    v_fmac_f32 v148, v158, v163
    v_fmac_f32 v149, v159, v163
    v_lshlrev_b32 v158, 16, v71
    v_and_b32 v159, 0xffff0000, v71
    v_fmac_f32 v150, v158, v163
    v_fmac_f32 v151, v159, v163
    v_lshlrev_b32 v158, 16, v72
    v_and_b32 v159, 0xffff0000, v72
    v_fmac_f32 v144, v158, v164
    v_fmac_f32 v145, v159, v164
    v_lshlrev_b32 v158, 16, v73
    v_and_b32 v159, 0xffff0000, v73
    v_fmac_f32 v146, v158, v164
    v_fmac_f32 v147, v159, v164
    v_lshlrev_b32 v158, 16, v74
    v_and_b32 v159, 0xffff0000, v74
    v_fmac_f32 v148, v158, v164
    v_fmac_f32 v149, v159, v164
    v_lshlrev_b32 v158, 16, v75
    v_and_b32 v159, 0xffff0000, v75
    v_fmac_f32 v150, v158, v164
    v_fmac_f32 v151, v159, v164
    v_lshlrev_b32 v158, 16, v76
    v_and_b32 v159, 0xffff0000, v76
    v_fmac_f32 v144, v158, v165
    v_fmac_f32 v145, v159, v165
    v_lshlrev_b32 v158, 16, v77
    v_and_b32 v159, 0xffff0000, v77
    v_fmac_f32 v146, v158, v165
    v_fmac_f32 v147, v159, v165
    v_lshlrev_b32 v158, 16, v78
    v_and_b32 v159, 0xffff0000, v78
    v_fmac_f32 v148, v158, v165
    v_fmac_f32 v149, v159, v165
    v_lshlrev_b32 v158, 16, v79
    v_and_b32 v159, 0xffff0000, v79
    v_fmac_f32 v150, v158, v165
    v_fmac_f32 v151, v159, v165
    v_lshlrev_b32 v158, 16, v80
    v_and_b32 v159, 0xffff0000, v80
    v_fmac_f32 v144, v158, v166
    v_fmac_f32 v145, v159, v166
    v_lshlrev_b32 v158, 16, v81
    v_and_b32 v159, 0xffff0000, v81
    v_fmac_f32 v146, v158, v166
    v_fmac_f32 v147, v159, v166
    v_lshlrev_b32 v158, 16, v82
    v_and_b32 v159, 0xffff0000, v82
    v_fmac_f32 v148, v158, v166
    v_fmac_f32 v149, v159, v166
    v_lshlrev_b32 v158, 16, v83
    v_and_b32 v159, 0xffff0000, v83
    v_fmac_f32 v150, v158, v166
    v_fmac_f32 v151, v159, v166
    v_lshlrev_b32 v158, 16, v84
    v_and_b32 v159, 0xffff0000, v84
    v_fmac_f32 v144, v158, v167
    v_fmac_f32 v145, v159, v167
    v_lshlrev_b32 v158, 16, v85
    v_and_b32 v159, 0xffff0000, v85
    v_fmac_f32 v146, v158, v167
    v_fmac_f32 v147, v159, v167
    v_lshlrev_b32 v158, 16, v86
    v_and_b32 v159, 0xffff0000, v86
    v_fmac_f32 v148, v158, v167
    v_fmac_f32 v149, v159, v167
    v_lshlrev_b32 v158, 16, v87
    v_and_b32 v159, 0xffff0000, v87
    v_fmac_f32 v150, v158, v167
    v_fmac_f32 v151, v159, v167
    buffer_load_dwordx4 v[56:59], v4, s[20:23], s91 offen offset:0 sc1 nt
    buffer_load_dwordx4 v[60:63], v4, s[20:23], s91 offen offset:768 sc1 nt
    buffer_load_dwordx4 v[64:67], v4, s[20:23], s91 offen offset:1536 sc1 nt
    buffer_load_dwordx4 v[68:71], v4, s[20:23], s91 offen offset:2304 sc1 nt
    buffer_load_dwordx4 v[72:75], v6, s[20:23], s91 offen offset:0 sc1 nt
    buffer_load_dwordx4 v[76:79], v6, s[20:23], s91 offen offset:768 sc1 nt
    buffer_load_dwordx4 v[80:83], v6, s[20:23], s91 offen offset:1536 sc1 nt
    buffer_load_dwordx4 v[84:87], v6, s[20:23], s91 offen offset:2304 sc1 nt
L_loop:
    s_waitcnt vmcnt(22)
    v_mfma_f32_16x16x32_bf16 v[168:171], v[8:11], v[88:91], 0
    v_mfma_f32_16x16x32_bf16 v[168:171], v[12:15], v[92:95], v[168:171]
    v_mfma_f32_16x16x32_bf16 v[168:171], v[16:19], v[96:99], v[168:171]
    v_mfma_f32_16x16x32_bf16 v[168:171], v[20:23], v[100:103], v[168:171]
    v_mfma_f32_16x16x32_bf16 v[168:171], v[24:27], v[104:107], v[168:171]
    v_mfma_f32_16x16x32_bf16 v[168:171], v[28:31], v[108:111], v[168:171]
    v_readfirstlane_b32 s91, v183
    s_nop 3
    s_cmp_ge_u32 s91, 0x1000
    s_cbranch_scc1 L_idx2
    s_waitcnt vmcnt(0)
    v_readfirstlane_b32 s91, v183
    s_nop 3
L_idx2:
    s_sub_u32 s91, s91, 3904
    s_cmp_ge_u32 s91, 512
    s_cbranch_scc1 L_drain1
    s_mul_i32 s91, s91, 6144
    buffer_load_dwordx4 v[88:91], v2, s[16:19], s91 offen offset:0 sc1 nt
    buffer_load_dwordx4 v[92:95], v2, s[16:19], s91 offen offset:64 sc1 nt
    buffer_load_dwordx4 v[96:99], v2, s[16:19], s91 offen offset:128 sc1 nt
    buffer_load_dwordx4 v[100:103], v2, s[16:19], s91 offen offset:192 sc1 nt
    buffer_load_dwordx4 v[104:107], v2, s[16:19], s91 offen offset:256 sc1 nt
    buffer_load_dwordx4 v[108:111], v2, s[16:19], s91 offen offset:320 sc1 nt
    v_mov_b32 v183, 1
    v_cmp_eq_u32 vcc, 0, v1
    s_and_saveexec_b64 s[92:93], vcc
    buffer_atomic_add v183, off, s[24:27], s96 sc0
    s_or_b64 exec, exec, s[92:93]
    s_nop 8
    v_cvt_pk_bf16_f32 v154, v168, v168
    v_lshlrev_b32 v154, 16, v154
    v_mul_f32 v154, 0x3d93cd3a, v154
    v_cvt_pk_bf16_f32 v154, v154, v154
    v_lshlrev_b32 v154, 16, v154
    v_mul_f32 v154, 0x3fb8aa3b, v154
    s_nop 1
    v_max_f32_dpp v155, v154, v154 row_ror:8 row_mask:0xf bank_mask:0xf
    s_nop 1
    v_max_f32_dpp v155, v155, v155 row_ror:4 row_mask:0xf bank_mask:0xf
    s_nop 1
    v_max_f32_dpp v155, v155, v155 row_ror:2 row_mask:0xf bank_mask:0xf
    s_nop 1
    v_max_f32_dpp v155, v155, v155 row_ror:1 row_mask:0xf bank_mask:0xf
    v_max_f32 v155, v155, v152
    v_sub_f32 v156, v152, v155
    v_sub_f32 v157, v154, v155
    v_exp_f32 v156, v156
    v_exp_f32 v157, v157
    v_mov_b32 v152, v155
    v_fma_f32 v153, v153, v156, v157
    ds_bpermute_b32 v160, v172, v157
    ds_bpermute_b32 v161, v173, v157
    ds_bpermute_b32 v162, v174, v157
    ds_bpermute_b32 v163, v175, v157
    ds_bpermute_b32 v164, v176, v157
    ds_bpermute_b32 v165, v177, v157
    ds_bpermute_b32 v166, v178, v157
    ds_bpermute_b32 v167, v179, v157
    v_mul_f32 v144, v144, v156
    v_mul_f32 v145, v145, v156
    v_mul_f32 v146, v146, v156
    v_mul_f32 v147, v147, v156
    v_mul_f32 v148, v148, v156
    v_mul_f32 v149, v149, v156
    v_mul_f32 v150, v150, v156
    v_mul_f32 v151, v151, v156
    s_waitcnt lgkmcnt(0)
    s_waitcnt vmcnt(27)
    v_lshlrev_b32 v158, 16, v112
    v_and_b32 v159, 0xffff0000, v112
    v_fmac_f32 v144, v158, v160
    v_fmac_f32 v145, v159, v160
    v_lshlrev_b32 v158, 16, v113
    v_and_b32 v159, 0xffff0000, v113
    v_fmac_f32 v146, v158, v160
    v_fmac_f32 v147, v159, v160
    v_lshlrev_b32 v158, 16, v114
    v_and_b32 v159, 0xffff0000, v114
    v_fmac_f32 v148, v158, v160
    v_fmac_f32 v149, v159, v160
    v_lshlrev_b32 v158, 16, v115
    v_and_b32 v159, 0xffff0000, v115
    v_fmac_f32 v150, v158, v160
    v_fmac_f32 v151, v159, v160
    s_waitcnt vmcnt(26)
    v_lshlrev_b32 v158, 16, v116
    v_and_b32 v159, 0xffff0000, v116
    v_fmac_f32 v144, v158, v161
    v_fmac_f32 v145, v159, v161
    v_lshlrev_b32 v158, 16, v117
    v_and_b32 v159, 0xffff0000, v117
    v_fmac_f32 v146, v158, v161
    v_fmac_f32 v147, v159, v161
    v_lshlrev_b32 v158, 16, v118
    v_and_b32 v159, 0xffff0000, v118
    v_fmac_f32 v148, v158, v161
    v_fmac_f32 v149, v159, v161
    v_lshlrev_b32 v158, 16, v119
    v_and_b32 v159, 0xffff0000, v119
    v_fmac_f32 v150, v158, v161
    v_fmac_f32 v151, v159, v161
    s_waitcnt vmcnt(25)
    v_lshlrev_b32 v158, 16, v120
    v_and_b32 v159, 0xffff0000, v120
    v_fmac_f32 v144, v158, v162
    v_fmac_f32 v145, v159, v162
    v_lshlrev_b32 v158, 16, v121
    v_and_b32 v159, 0xffff0000, v121
    v_fmac_f32 v146, v158, v162
    v_fmac_f32 v147, v159, v162
    v_lshlrev_b32 v158, 16, v122
    v_and_b32 v159, 0xffff0000, v122
    v_fmac_f32 v148, v158, v162
    v_fmac_f32 v149, v159, v162
    v_lshlrev_b32 v158, 16, v123
    v_and_b32 v159, 0xffff0000, v123
    v_fmac_f32 v150, v158, v162
    v_fmac_f32 v151, v159, v162
    s_waitcnt vmcnt(24)
    v_lshlrev_b32 v158, 16, v124
    v_and_b32 v159, 0xffff0000, v124
    v_fmac_f32 v144, v158, v163
    v_fmac_f32 v145, v159, v163
    v_lshlrev_b32 v158, 16, v125
    v_and_b32 v159, 0xffff0000, v125
    v_fmac_f32 v146, v158, v163
    v_fmac_f32 v147, v159, v163
    v_lshlrev_b32 v158, 16, v126
    v_and_b32 v159, 0xffff0000, v126
    v_fmac_f32 v148, v158, v163
    v_fmac_f32 v149, v159, v163
    v_lshlrev_b32 v158, 16, v127
    v_and_b32 v159, 0xffff0000, v127
    v_fmac_f32 v150, v158, v163
    v_fmac_f32 v151, v159, v163
    s_waitcnt vmcnt(23)
    v_lshlrev_b32 v158, 16, v128
    v_and_b32 v159, 0xffff0000, v128
    v_fmac_f32 v144, v158, v164
    v_fmac_f32 v145, v159, v164
    v_lshlrev_b32 v158, 16, v129
    v_and_b32 v159, 0xffff0000, v129
    v_fmac_f32 v146, v158, v164
    v_fmac_f32 v147, v159, v164
    v_lshlrev_b32 v158, 16, v130
    v_and_b32 v159, 0xffff0000, v130
    v_fmac_f32 v148, v158, v164
    v_fmac_f32 v149, v159, v164
    v_lshlrev_b32 v158, 16, v131
    v_and_b32 v159, 0xffff0000, v131
    v_fmac_f32 v150, v158, v164
    v_fmac_f32 v151, v159, v164
    s_waitcnt vmcnt(22)
    v_lshlrev_b32 v158, 16, v132
    v_and_b32 v159, 0xffff0000, v132
    v_fmac_f32 v144, v158, v165
    v_fmac_f32 v145, v159, v165
    v_lshlrev_b32 v158, 16, v133
    v_and_b32 v159, 0xffff0000, v133
    v_fmac_f32 v146, v158, v165
    v_fmac_f32 v147, v159, v165
    v_lshlrev_b32 v158, 16, v134
    v_and_b32 v159, 0xffff0000, v134
    v_fmac_f32 v148, v158, v165
    v_fmac_f32 v149, v159, v165
    v_lshlrev_b32 v158, 16, v135
    v_and_b32 v159, 0xffff0000, v135
    v_fmac_f32 v150, v158, v165
    v_fmac_f32 v151, v159, v165
    s_waitcnt vmcnt(21)
    v_lshlrev_b32 v158, 16, v136
    v_and_b32 v159, 0xffff0000, v136
    v_fmac_f32 v144, v158, v166
    v_fmac_f32 v145, v159, v166
    v_lshlrev_b32 v158, 16, v137
    v_and_b32 v159, 0xffff0000, v137
    v_fmac_f32 v146, v158, v166
    v_fmac_f32 v147, v159, v166
    v_lshlrev_b32 v158, 16, v138
    v_and_b32 v159, 0xffff0000, v138
    v_fmac_f32 v148, v158, v166
    v_fmac_f32 v149, v159, v166
    v_lshlrev_b32 v158, 16, v139
    v_and_b32 v159, 0xffff0000, v139
    v_fmac_f32 v150, v158, v166
    v_fmac_f32 v151, v159, v166
    s_waitcnt vmcnt(20)
    v_lshlrev_b32 v158, 16, v140
    v_and_b32 v159, 0xffff0000, v140
    v_fmac_f32 v144, v158, v167
    v_fmac_f32 v145, v159, v167
    v_lshlrev_b32 v158, 16, v141
    v_and_b32 v159, 0xffff0000, v141
    v_fmac_f32 v146, v158, v167
    v_fmac_f32 v147, v159, v167
    v_lshlrev_b32 v158, 16, v142
    v_and_b32 v159, 0xffff0000, v142
    v_fmac_f32 v148, v158, v167
    v_fmac_f32 v149, v159, v167
    v_lshlrev_b32 v158, 16, v143
    v_and_b32 v159, 0xffff0000, v143
    v_fmac_f32 v150, v158, v167
    v_fmac_f32 v151, v159, v167
    buffer_load_dwordx4 v[112:115], v4, s[20:23], s91 offen offset:0 sc1 nt
    buffer_load_dwordx4 v[116:119], v4, s[20:23], s91 offen offset:768 sc1 nt
    buffer_load_dwordx4 v[120:123], v4, s[20:23], s91 offen offset:1536 sc1 nt
    buffer_load_dwordx4 v[124:127], v4, s[20:23], s91 offen offset:2304 sc1 nt
    buffer_load_dwordx4 v[128:131], v6, s[20:23], s91 offen offset:0 sc1 nt
    buffer_load_dwordx4 v[132:135], v6, s[20:23], s91 offen offset:768 sc1 nt
    buffer_load_dwordx4 v[136:139], v6, s[20:23], s91 offen offset:1536 sc1 nt
    buffer_load_dwordx4 v[140:143], v6, s[20:23], s91 offen offset:2304 sc1 nt
    s_waitcnt vmcnt(22)
    v_mfma_f32_16x16x32_bf16 v[168:171], v[8:11], v[32:35], 0
    v_mfma_f32_16x16x32_bf16 v[168:171], v[12:15], v[36:39], v[168:171]
    v_mfma_f32_16x16x32_bf16 v[168:171], v[16:19], v[40:43], v[168:171]
    v_mfma_f32_16x16x32_bf16 v[168:171], v[20:23], v[44:47], v[168:171]
    v_mfma_f32_16x16x32_bf16 v[168:171], v[24:27], v[48:51], v[168:171]
    v_mfma_f32_16x16x32_bf16 v[168:171], v[28:31], v[52:55], v[168:171]
    v_readfirstlane_b32 s91, v182
    s_nop 3
    s_cmp_ge_u32 s91, 0x1000
    s_cbranch_scc1 L_idx3
    s_waitcnt vmcnt(0)
    v_readfirstlane_b32 s91, v182
    s_nop 3
L_idx3:
    s_sub_u32 s91, s91, 3904
    s_cmp_ge_u32 s91, 512
    s_cbranch_scc1 L_drain0
    s_mul_i32 s91, s91, 6144
    buffer_load_dwordx4 v[32:35], v2, s[16:19], s91 offen offset:0 sc1 nt
    buffer_load_dwordx4 v[36:39], v2, s[16:19], s91 offen offset:64 sc1 nt
    buffer_load_dwordx4 v[40:43], v2, s[16:19], s91 offen offset:128 sc1 nt
    buffer_load_dwordx4 v[44:47], v2, s[16:19], s91 offen offset:192 sc1 nt
    buffer_load_dwordx4 v[48:51], v2, s[16:19], s91 offen offset:256 sc1 nt
    buffer_load_dwordx4 v[52:55], v2, s[16:19], s91 offen offset:320 sc1 nt
    v_mov_b32 v182, 1
    v_cmp_eq_u32 vcc, 0, v1
    s_and_saveexec_b64 s[92:93], vcc
    buffer_atomic_add v182, off, s[24:27], s96 sc0
    s_or_b64 exec, exec, s[92:93]
    s_nop 8
    v_cvt_pk_bf16_f32 v154, v168, v168
    v_lshlrev_b32 v154, 16, v154
    v_mul_f32 v154, 0x3d93cd3a, v154
    v_cvt_pk_bf16_f32 v154, v154, v154
    v_lshlrev_b32 v154, 16, v154
    v_mul_f32 v154, 0x3fb8aa3b, v154
    s_nop 1
    v_max_f32_dpp v155, v154, v154 row_ror:8 row_mask:0xf bank_mask:0xf
    s_nop 1
    v_max_f32_dpp v155, v155, v155 row_ror:4 row_mask:0xf bank_mask:0xf
    s_nop 1
    v_max_f32_dpp v155, v155, v155 row_ror:2 row_mask:0xf bank_mask:0xf
    s_nop 1
    v_max_f32_dpp v155, v155, v155 row_ror:1 row_mask:0xf bank_mask:0xf
    v_max_f32 v155, v155, v152
    v_sub_f32 v156, v152, v155
    v_sub_f32 v157, v154, v155
    v_exp_f32 v156, v156
    v_exp_f32 v157, v157
    v_mov_b32 v152, v155
    v_fma_f32 v153, v153, v156, v157
    ds_bpermute_b32 v160, v172, v157
    ds_bpermute_b32 v161, v173, v157
    ds_bpermute_b32 v162, v174, v157
    ds_bpermute_b32 v163, v175, v157
    ds_bpermute_b32 v164, v176, v157
    ds_bpermute_b32 v165, v177, v157
    ds_bpermute_b32 v166, v178, v157
    ds_bpermute_b32 v167, v179, v157
    v_mul_f32 v144, v144, v156
    v_mul_f32 v145, v145, v156
    v_mul_f32 v146, v146, v156
    v_mul_f32 v147, v147, v156
    v_mul_f32 v148, v148, v156
    v_mul_f32 v149, v149, v156
    v_mul_f32 v150, v150, v156
    v_mul_f32 v151, v151, v156
    s_waitcnt lgkmcnt(0)
    s_waitcnt vmcnt(27)
    v_lshlrev_b32 v158, 16, v56
    v_and_b32 v159, 0xffff0000, v56
    v_fmac_f32 v144, v158, v160
    v_fmac_f32 v145, v159, v160
    v_lshlrev_b32 v158, 16, v57
    v_and_b32 v159, 0xffff0000, v57
    v_fmac_f32 v146, v158, v160
    v_fmac_f32 v147, v159, v160
    v_lshlrev_b32 v158, 16, v58
    v_and_b32 v159, 0xffff0000, v58
    v_fmac_f32 v148, v158, v160
    v_fmac_f32 v149, v159, v160
    v_lshlrev_b32 v158, 16, v59
    v_and_b32 v159, 0xffff0000, v59
    v_fmac_f32 v150, v158, v160
    v_fmac_f32 v151, v159, v160
    s_waitcnt vmcnt(26)
    v_lshlrev_b32 v158, 16, v60
    v_and_b32 v159, 0xffff0000, v60
    v_fmac_f32 v144, v158, v161
    v_fmac_f32 v145, v159, v161
    v_lshlrev_b32 v158, 16, v61
    v_and_b32 v159, 0xffff0000, v61
    v_fmac_f32 v146, v158, v161
    v_fmac_f32 v147, v159, v161
    v_lshlrev_b32 v158, 16, v62
    v_and_b32 v159, 0xffff0000, v62
    v_fmac_f32 v148, v158, v161
    v_fmac_f32 v149, v159, v161
    v_lshlrev_b32 v158, 16, v63
    v_and_b32 v159, 0xffff0000, v63
    v_fmac_f32 v150, v158, v161
    v_fmac_f32 v151, v159, v161
    s_waitcnt vmcnt(25)
    v_lshlrev_b32 v158, 16, v64
    v_and_b32 v159, 0xffff0000, v64
    v_fmac_f32 v144, v158, v162
    v_fmac_f32 v145, v159, v162
    v_lshlrev_b32 v158, 16, v65
    v_and_b32 v159, 0xffff0000, v65
    v_fmac_f32 v146, v158, v162
    v_fmac_f32 v147, v159, v162
    v_lshlrev_b32 v158, 16, v66
    v_and_b32 v159, 0xffff0000, v66
    v_fmac_f32 v148, v158, v162
    v_fmac_f32 v149, v159, v162
    v_lshlrev_b32 v158, 16, v67
    v_and_b32 v159, 0xffff0000, v67
    v_fmac_f32 v150, v158, v162
    v_fmac_f32 v151, v159, v162
    s_waitcnt vmcnt(24)
    v_lshlrev_b32 v158, 16, v68
    v_and_b32 v159, 0xffff0000, v68
    v_fmac_f32 v144, v158, v163
    v_fmac_f32 v145, v159, v163
    v_lshlrev_b32 v158, 16, v69
    v_and_b32 v159, 0xffff0000, v69
    v_fmac_f32 v146, v158, v163
    v_fmac_f32 v147, v159, v163
    v_lshlrev_b32 v158, 16, v70
    v_and_b32 v159, 0xffff0000, v70
    v_fmac_f32 v148, v158, v163
    v_fmac_f32 v149, v159, v163
    v_lshlrev_b32 v158, 16, v71
    v_and_b32 v159, 0xffff0000, v71
    v_fmac_f32 v150, v158, v163
    v_fmac_f32 v151, v159, v163
    s_waitcnt vmcnt(23)
    v_lshlrev_b32 v158, 16, v72
    v_and_b32 v159, 0xffff0000, v72
    v_fmac_f32 v144, v158, v164
    v_fmac_f32 v145, v159, v164
    v_lshlrev_b32 v158, 16, v73
    v_and_b32 v159, 0xffff0000, v73
    v_fmac_f32 v146, v158, v164
    v_fmac_f32 v147, v159, v164
    v_lshlrev_b32 v158, 16, v74
    v_and_b32 v159, 0xffff0000, v74
    v_fmac_f32 v148, v158, v164
    v_fmac_f32 v149, v159, v164
    v_lshlrev_b32 v158, 16, v75
    v_and_b32 v159, 0xffff0000, v75
    v_fmac_f32 v150, v158, v164
    v_fmac_f32 v151, v159, v164
    s_waitcnt vmcnt(22)
    v_lshlrev_b32 v158, 16, v76
    v_and_b32 v159, 0xffff0000, v76
    v_fmac_f32 v144, v158, v165
    v_fmac_f32 v145, v159, v165
    v_lshlrev_b32 v158, 16, v77
    v_and_b32 v159, 0xffff0000, v77
    v_fmac_f32 v146, v158, v165
    v_fmac_f32 v147, v159, v165
    v_lshlrev_b32 v158, 16, v78
    v_and_b32 v159, 0xffff0000, v78
    v_fmac_f32 v148, v158, v165
    v_fmac_f32 v149, v159, v165
    v_lshlrev_b32 v158, 16, v79
    v_and_b32 v159, 0xffff0000, v79
    v_fmac_f32 v150, v158, v165
    v_fmac_f32 v151, v159, v165
    s_waitcnt vmcnt(21)
    v_lshlrev_b32 v158, 16, v80
    v_and_b32 v159, 0xffff0000, v80
    v_fmac_f32 v144, v158, v166
    v_fmac_f32 v145, v159, v166
    v_lshlrev_b32 v158, 16, v81
    v_and_b32 v159, 0xffff0000, v81
    v_fmac_f32 v146, v158, v166
    v_fmac_f32 v147, v159, v166
    v_lshlrev_b32 v158, 16, v82
    v_and_b32 v159, 0xffff0000, v82
    v_fmac_f32 v148, v158, v166
    v_fmac_f32 v149, v159, v166
    v_lshlrev_b32 v158, 16, v83
    v_and_b32 v159, 0xffff0000, v83
    v_fmac_f32 v150, v158, v166
    v_fmac_f32 v151, v159, v166
    s_waitcnt vmcnt(20)
    v_lshlrev_b32 v158, 16, v84
    v_and_b32 v159, 0xffff0000, v84
    v_fmac_f32 v144, v158, v167
    v_fmac_f32 v145, v159, v167
    v_lshlrev_b32 v158, 16, v85
    v_and_b32 v159, 0xffff0000, v85
    v_fmac_f32 v146, v158, v167
    v_fmac_f32 v147, v159, v167
    v_lshlrev_b32 v158, 16, v86
    v_and_b32 v159, 0xffff0000, v86
    v_fmac_f32 v148, v158, v167
    v_fmac_f32 v149, v159, v167
    v_lshlrev_b32 v158, 16, v87
    v_and_b32 v159, 0xffff0000, v87
    v_fmac_f32 v150, v158, v167
    v_fmac_f32 v151, v159, v167
    buffer_load_dwordx4 v[56:59], v4, s[20:23], s91 offen offset:0 sc1 nt
    buffer_load_dwordx4 v[60:63], v4, s[20:23], s91 offen offset:768 sc1 nt
    buffer_load_dwordx4 v[64:67], v4, s[20:23], s91 offen offset:1536 sc1 nt
    buffer_load_dwordx4 v[68:71], v4, s[20:23], s91 offen offset:2304 sc1 nt
    buffer_load_dwordx4 v[72:75], v6, s[20:23], s91 offen offset:0 sc1 nt
    buffer_load_dwordx4 v[76:79], v6, s[20:23], s91 offen offset:768 sc1 nt
    buffer_load_dwordx4 v[80:83], v6, s[20:23], s91 offen offset:1536 sc1 nt
    buffer_load_dwordx4 v[84:87], v6, s[20:23], s91 offen offset:2304 sc1 nt
    s_branch L_loop
L_drain1:
    s_mul_i32 s14, s11, 245760
    s_mul_i32 s15, s12, 160
    s_add_u32 s14, s14, s15
    buffer_load_dwordx4 v[88:91], v7, s[40:43], s14 offen
    s_add_u32 s14, s14, 61440
    buffer_load_dwordx4 v[92:95], v7, s[40:43], s14 offen
    s_add_u32 s14, s14, 61440
    buffer_load_dwordx4 v[96:99], v7, s[40:43], s14 offen
    s_add_u32 s14, s14, 61440
    buffer_load_dwordx4 v[100:103], v7, s[40:43], s14 offen
    s_add_u32 s14, s14, 61440
    s_mul_i32 s14, s11, 61440
    s_add_u32 s14, s14, s15
    buffer_load_dwordx4 v[104:107], v7, s[44:47], s14 offen
    s_nop 8
    v_cvt_pk_bf16_f32 v154, v168, v168
    v_lshlrev_b32 v154, 16, v154
    v_mul_f32 v154, 0x3d93cd3a, v154
    v_cvt_pk_bf16_f32 v154, v154, v154
    v_lshlrev_b32 v154, 16, v154
    v_mul_f32 v154, 0x3fb8aa3b, v154
    s_nop 1
    v_max_f32_dpp v155, v154, v154 row_ror:8 row_mask:0xf bank_mask:0xf
    s_nop 1
    v_max_f32_dpp v155, v155, v155 row_ror:4 row_mask:0xf bank_mask:0xf
    s_nop 1
    v_max_f32_dpp v155, v155, v155 row_ror:2 row_mask:0xf bank_mask:0xf
    s_nop 1
    v_max_f32_dpp v155, v155, v155 row_ror:1 row_mask:0xf bank_mask:0xf
    v_max_f32 v155, v155, v152
    v_sub_f32 v156, v152, v155
    v_sub_f32 v157, v154, v155
    v_exp_f32 v156, v156
    v_exp_f32 v157, v157
    v_mov_b32 v152, v155
    v_fma_f32 v153, v153, v156, v157
    ds_bpermute_b32 v160, v172, v157
    ds_bpermute_b32 v161, v173, v157
    ds_bpermute_b32 v162, v174, v157
    ds_bpermute_b32 v163, v175, v157
    ds_bpermute_b32 v164, v176, v157
    ds_bpermute_b32 v165, v177, v157
    ds_bpermute_b32 v166, v178, v157
    ds_bpermute_b32 v167, v179, v157
    v_mul_f32 v144, v144, v156
    v_mul_f32 v145, v145, v156
    v_mul_f32 v146, v146, v156
    v_mul_f32 v147, v147, v156
    v_mul_f32 v148, v148, v156
    v_mul_f32 v149, v149, v156
    v_mul_f32 v150, v150, v156
    v_mul_f32 v151, v151, v156
    s_waitcnt lgkmcnt(0)
    s_waitcnt vmcnt(26)
    v_lshlrev_b32 v158, 16, v112
    v_and_b32 v159, 0xffff0000, v112
    v_fmac_f32 v144, v158, v160
    v_fmac_f32 v145, v159, v160
    v_lshlrev_b32 v158, 16, v113
    v_and_b32 v159, 0xffff0000, v113
    v_fmac_f32 v146, v158, v160
    v_fmac_f32 v147, v159, v160
    v_lshlrev_b32 v158, 16, v114
    v_and_b32 v159, 0xffff0000, v114
    v_fmac_f32 v148, v158, v160
    v_fmac_f32 v149, v159, v160
    v_lshlrev_b32 v158, 16, v115
    v_and_b32 v159, 0xffff0000, v115
    v_fmac_f32 v150, v158, v160
    v_fmac_f32 v151, v159, v160
    s_waitcnt vmcnt(25)
    v_lshlrev_b32 v158, 16, v116
    v_and_b32 v159, 0xffff0000, v116
    v_fmac_f32 v144, v158, v161
    v_fmac_f32 v145, v159, v161
    v_lshlrev_b32 v158, 16, v117
    v_and_b32 v159, 0xffff0000, v117
    v_fmac_f32 v146, v158, v161
    v_fmac_f32 v147, v159, v161
    v_lshlrev_b32 v158, 16, v118
    v_and_b32 v159, 0xffff0000, v118
    v_fmac_f32 v148, v158, v161
    v_fmac_f32 v149, v159, v161
    v_lshlrev_b32 v158, 16, v119
    v_and_b32 v159, 0xffff0000, v119
    v_fmac_f32 v150, v158, v161
    v_fmac_f32 v151, v159, v161
    s_waitcnt vmcnt(24)
    v_lshlrev_b32 v158, 16, v120
    v_and_b32 v159, 0xffff0000, v120
    v_fmac_f32 v144, v158, v162
    v_fmac_f32 v145, v159, v162
    v_lshlrev_b32 v158, 16, v121
    v_and_b32 v159, 0xffff0000, v121
    v_fmac_f32 v146, v158, v162
    v_fmac_f32 v147, v159, v162
    v_lshlrev_b32 v158, 16, v122
    v_and_b32 v159, 0xffff0000, v122
    v_fmac_f32 v148, v158, v162
    v_fmac_f32 v149, v159, v162
    v_lshlrev_b32 v158, 16, v123
    v_and_b32 v159, 0xffff0000, v123
    v_fmac_f32 v150, v158, v162
    v_fmac_f32 v151, v159, v162
    s_waitcnt vmcnt(23)
    v_lshlrev_b32 v158, 16, v124
    v_and_b32 v159, 0xffff0000, v124
    v_fmac_f32 v144, v158, v163
    v_fmac_f32 v145, v159, v163
    v_lshlrev_b32 v158, 16, v125
    v_and_b32 v159, 0xffff0000, v125
    v_fmac_f32 v146, v158, v163
    v_fmac_f32 v147, v159, v163
    v_lshlrev_b32 v158, 16, v126
    v_and_b32 v159, 0xffff0000, v126
    v_fmac_f32 v148, v158, v163
    v_fmac_f32 v149, v159, v163
    v_lshlrev_b32 v158, 16, v127
    v_and_b32 v159, 0xffff0000, v127
    v_fmac_f32 v150, v158, v163
    v_fmac_f32 v151, v159, v163
    s_waitcnt vmcnt(22)
    v_lshlrev_b32 v158, 16, v128
    v_and_b32 v159, 0xffff0000, v128
    v_fmac_f32 v144, v158, v164
    v_fmac_f32 v145, v159, v164
    v_lshlrev_b32 v158, 16, v129
    v_and_b32 v159, 0xffff0000, v129
    v_fmac_f32 v146, v158, v164
    v_fmac_f32 v147, v159, v164
    v_lshlrev_b32 v158, 16, v130
    v_and_b32 v159, 0xffff0000, v130
    v_fmac_f32 v148, v158, v164
    v_fmac_f32 v149, v159, v164
    v_lshlrev_b32 v158, 16, v131
    v_and_b32 v159, 0xffff0000, v131
    v_fmac_f32 v150, v158, v164
    v_fmac_f32 v151, v159, v164
    s_waitcnt vmcnt(21)
    v_lshlrev_b32 v158, 16, v132
    v_and_b32 v159, 0xffff0000, v132
    v_fmac_f32 v144, v158, v165
    v_fmac_f32 v145, v159, v165
    v_lshlrev_b32 v158, 16, v133
    v_and_b32 v159, 0xffff0000, v133
    v_fmac_f32 v146, v158, v165
    v_fmac_f32 v147, v159, v165
    v_lshlrev_b32 v158, 16, v134
    v_and_b32 v159, 0xffff0000, v134
    v_fmac_f32 v148, v158, v165
    v_fmac_f32 v149, v159, v165
    v_lshlrev_b32 v158, 16, v135
    v_and_b32 v159, 0xffff0000, v135
    v_fmac_f32 v150, v158, v165
    v_fmac_f32 v151, v159, v165
    s_waitcnt vmcnt(20)
    v_lshlrev_b32 v158, 16, v136
    v_and_b32 v159, 0xffff0000, v136
    v_fmac_f32 v144, v158, v166
    v_fmac_f32 v145, v159, v166
    v_lshlrev_b32 v158, 16, v137
    v_and_b32 v159, 0xffff0000, v137
    v_fmac_f32 v146, v158, v166
    v_fmac_f32 v147, v159, v166
    v_lshlrev_b32 v158, 16, v138
    v_and_b32 v159, 0xffff0000, v138
    v_fmac_f32 v148, v158, v166
    v_fmac_f32 v149, v159, v166
    v_lshlrev_b32 v158, 16, v139
    v_and_b32 v159, 0xffff0000, v139
    v_fmac_f32 v150, v158, v166
    v_fmac_f32 v151, v159, v166
    s_waitcnt vmcnt(19)
    v_lshlrev_b32 v158, 16, v140
    v_and_b32 v159, 0xffff0000, v140
    v_fmac_f32 v144, v158, v167
    v_fmac_f32 v145, v159, v167
    v_lshlrev_b32 v158, 16, v141
    v_and_b32 v159, 0xffff0000, v141
    v_fmac_f32 v146, v158, v167
    v_fmac_f32 v147, v159, v167
    v_lshlrev_b32 v158, 16, v142
    v_and_b32 v159, 0xffff0000, v142
    v_fmac_f32 v148, v158, v167
    v_fmac_f32 v149, v159, v167
    v_lshlrev_b32 v158, 16, v143
    v_and_b32 v159, 0xffff0000, v143
    v_fmac_f32 v150, v158, v167
    v_fmac_f32 v151, v159, v167
    s_waitcnt vmcnt(13)
    v_mfma_f32_16x16x32_bf16 v[168:171], v[8:11], v[32:35], 0
    v_mfma_f32_16x16x32_bf16 v[168:171], v[12:15], v[36:39], v[168:171]
    v_mfma_f32_16x16x32_bf16 v[168:171], v[16:19], v[40:43], v[168:171]
    v_mfma_f32_16x16x32_bf16 v[168:171], v[20:23], v[44:47], v[168:171]
    v_mfma_f32_16x16x32_bf16 v[168:171], v[24:27], v[48:51], v[168:171]
    v_mfma_f32_16x16x32_bf16 v[168:171], v[28:31], v[52:55], v[168:171]
    s_nop 8
    v_cvt_pk_bf16_f32 v154, v168, v168
    v_lshlrev_b32 v154, 16, v154
    v_mul_f32 v154, 0x3d93cd3a, v154
    v_cvt_pk_bf16_f32 v154, v154, v154
    v_lshlrev_b32 v154, 16, v154
    v_mul_f32 v154, 0x3fb8aa3b, v154
    s_nop 1
    v_max_f32_dpp v155, v154, v154 row_ror:8 row_mask:0xf bank_mask:0xf
    s_nop 1
    v_max_f32_dpp v155, v155, v155 row_ror:4 row_mask:0xf bank_mask:0xf
    s_nop 1
    v_max_f32_dpp v155, v155, v155 row_ror:2 row_mask:0xf bank_mask:0xf
    s_nop 1
    v_max_f32_dpp v155, v155, v155 row_ror:1 row_mask:0xf bank_mask:0xf
    v_max_f32 v155, v155, v152
    v_sub_f32 v156, v152, v155
    v_sub_f32 v157, v154, v155
    v_exp_f32 v156, v156
    v_exp_f32 v157, v157
    v_mov_b32 v152, v155
    v_fma_f32 v153, v153, v156, v157
    ds_bpermute_b32 v160, v172, v157
    ds_bpermute_b32 v161, v173, v157
    ds_bpermute_b32 v162, v174, v157
    ds_bpermute_b32 v163, v175, v157
    ds_bpermute_b32 v164, v176, v157
    ds_bpermute_b32 v165, v177, v157
    ds_bpermute_b32 v166, v178, v157
    ds_bpermute_b32 v167, v179, v157
    v_mul_f32 v144, v144, v156
    v_mul_f32 v145, v145, v156
    v_mul_f32 v146, v146, v156
    v_mul_f32 v147, v147, v156
    v_mul_f32 v148, v148, v156
    v_mul_f32 v149, v149, v156
    v_mul_f32 v150, v150, v156
    v_mul_f32 v151, v151, v156
    s_waitcnt lgkmcnt(0)
    s_waitcnt vmcnt(12)
    v_lshlrev_b32 v158, 16, v56
    v_and_b32 v159, 0xffff0000, v56
    v_fmac_f32 v144, v158, v160
    v_fmac_f32 v145, v159, v160
    v_lshlrev_b32 v158, 16, v57
    v_and_b32 v159, 0xffff0000, v57
    v_fmac_f32 v146, v158, v160
    v_fmac_f32 v147, v159, v160
    v_lshlrev_b32 v158, 16, v58
    v_and_b32 v159, 0xffff0000, v58
    v_fmac_f32 v148, v158, v160
    v_fmac_f32 v149, v159, v160
    v_lshlrev_b32 v158, 16, v59
    v_and_b32 v159, 0xffff0000, v59
    v_fmac_f32 v150, v158, v160
    v_fmac_f32 v151, v159, v160
    s_waitcnt vmcnt(11)
    v_lshlrev_b32 v158, 16, v60
    v_and_b32 v159, 0xffff0000, v60
    v_fmac_f32 v144, v158, v161
    v_fmac_f32 v145, v159, v161
    v_lshlrev_b32 v158, 16, v61
    v_and_b32 v159, 0xffff0000, v61
    v_fmac_f32 v146, v158, v161
    v_fmac_f32 v147, v159, v161
    v_lshlrev_b32 v158, 16, v62
    v_and_b32 v159, 0xffff0000, v62
    v_fmac_f32 v148, v158, v161
    v_fmac_f32 v149, v159, v161
    v_lshlrev_b32 v158, 16, v63
    v_and_b32 v159, 0xffff0000, v63
    v_fmac_f32 v150, v158, v161
    v_fmac_f32 v151, v159, v161
    s_waitcnt vmcnt(10)
    v_lshlrev_b32 v158, 16, v64
    v_and_b32 v159, 0xffff0000, v64
    v_fmac_f32 v144, v158, v162
    v_fmac_f32 v145, v159, v162
    v_lshlrev_b32 v158, 16, v65
    v_and_b32 v159, 0xffff0000, v65
    v_fmac_f32 v146, v158, v162
    v_fmac_f32 v147, v159, v162
    v_lshlrev_b32 v158, 16, v66
    v_and_b32 v159, 0xffff0000, v66
    v_fmac_f32 v148, v158, v162
    v_fmac_f32 v149, v159, v162
    v_lshlrev_b32 v158, 16, v67
    v_and_b32 v159, 0xffff0000, v67
    v_fmac_f32 v150, v158, v162
    v_fmac_f32 v151, v159, v162
    s_waitcnt vmcnt(9)
    v_lshlrev_b32 v158, 16, v68
    v_and_b32 v159, 0xffff0000, v68
    v_fmac_f32 v144, v158, v163
    v_fmac_f32 v145, v159, v163
    v_lshlrev_b32 v158, 16, v69
    v_and_b32 v159, 0xffff0000, v69
    v_fmac_f32 v146, v158, v163
    v_fmac_f32 v147, v159, v163
    v_lshlrev_b32 v158, 16, v70
    v_and_b32 v159, 0xffff0000, v70
    v_fmac_f32 v148, v158, v163
    v_fmac_f32 v149, v159, v163
    v_lshlrev_b32 v158, 16, v71
    v_and_b32 v159, 0xffff0000, v71
    v_fmac_f32 v150, v158, v163
    v_fmac_f32 v151, v159, v163
    s_waitcnt vmcnt(8)
    v_lshlrev_b32 v158, 16, v72
    v_and_b32 v159, 0xffff0000, v72
    v_fmac_f32 v144, v158, v164
    v_fmac_f32 v145, v159, v164
    v_lshlrev_b32 v158, 16, v73
    v_and_b32 v159, 0xffff0000, v73
    v_fmac_f32 v146, v158, v164
    v_fmac_f32 v147, v159, v164
    v_lshlrev_b32 v158, 16, v74
    v_and_b32 v159, 0xffff0000, v74
    v_fmac_f32 v148, v158, v164
    v_fmac_f32 v149, v159, v164
    v_lshlrev_b32 v158, 16, v75
    v_and_b32 v159, 0xffff0000, v75
    v_fmac_f32 v150, v158, v164
    v_fmac_f32 v151, v159, v164
    s_waitcnt vmcnt(7)
    v_lshlrev_b32 v158, 16, v76
    v_and_b32 v159, 0xffff0000, v76
    v_fmac_f32 v144, v158, v165
    v_fmac_f32 v145, v159, v165
    v_lshlrev_b32 v158, 16, v77
    v_and_b32 v159, 0xffff0000, v77
    v_fmac_f32 v146, v158, v165
    v_fmac_f32 v147, v159, v165
    v_lshlrev_b32 v158, 16, v78
    v_and_b32 v159, 0xffff0000, v78
    v_fmac_f32 v148, v158, v165
    v_fmac_f32 v149, v159, v165
    v_lshlrev_b32 v158, 16, v79
    v_and_b32 v159, 0xffff0000, v79
    v_fmac_f32 v150, v158, v165
    v_fmac_f32 v151, v159, v165
    s_waitcnt vmcnt(6)
    v_lshlrev_b32 v158, 16, v80
    v_and_b32 v159, 0xffff0000, v80
    v_fmac_f32 v144, v158, v166
    v_fmac_f32 v145, v159, v166
    v_lshlrev_b32 v158, 16, v81
    v_and_b32 v159, 0xffff0000, v81
    v_fmac_f32 v146, v158, v166
    v_fmac_f32 v147, v159, v166
    v_lshlrev_b32 v158, 16, v82
    v_and_b32 v159, 0xffff0000, v82
    v_fmac_f32 v148, v158, v166
    v_fmac_f32 v149, v159, v166
    v_lshlrev_b32 v158, 16, v83
    v_and_b32 v159, 0xffff0000, v83
    v_fmac_f32 v150, v158, v166
    v_fmac_f32 v151, v159, v166
    s_waitcnt vmcnt(5)
    v_lshlrev_b32 v158, 16, v84
    v_and_b32 v159, 0xffff0000, v84
    v_fmac_f32 v144, v158, v167
    v_fmac_f32 v145, v159, v167
    v_lshlrev_b32 v158, 16, v85
    v_and_b32 v159, 0xffff0000, v85
    v_fmac_f32 v146, v158, v167
    v_fmac_f32 v147, v159, v167
    v_lshlrev_b32 v158, 16, v86
    v_and_b32 v159, 0xffff0000, v86
    v_fmac_f32 v148, v158, v167
    v_fmac_f32 v149, v159, v167
    v_lshlrev_b32 v158, 16, v87
    v_and_b32 v159, 0xffff0000, v87
    v_fmac_f32 v150, v158, v167
    v_fmac_f32 v151, v159, v167
    s_mov_b32 s94, 88
    s_branch L_fin1
L_drain0:
    s_mul_i32 s14, s11, 245760
    s_mul_i32 s15, s12, 160
    s_add_u32 s14, s14, s15
    buffer_load_dwordx4 v[32:35], v7, s[40:43], s14 offen
    s_add_u32 s14, s14, 61440
    buffer_load_dwordx4 v[36:39], v7, s[40:43], s14 offen
    s_add_u32 s14, s14, 61440
    buffer_load_dwordx4 v[40:43], v7, s[40:43], s14 offen
    s_add_u32 s14, s14, 61440
    buffer_load_dwordx4 v[44:47], v7, s[40:43], s14 offen
    s_add_u32 s14, s14, 61440
    s_mul_i32 s14, s11, 61440
    s_add_u32 s14, s14, s15
    buffer_load_dwordx4 v[48:51], v7, s[44:47], s14 offen
    s_nop 8
    v_cvt_pk_bf16_f32 v154, v168, v168
    v_lshlrev_b32 v154, 16, v154
    v_mul_f32 v154, 0x3d93cd3a, v154
    v_cvt_pk_bf16_f32 v154, v154, v154
    v_lshlrev_b32 v154, 16, v154
    v_mul_f32 v154, 0x3fb8aa3b, v154
    s_nop 1
    v_max_f32_dpp v155, v154, v154 row_ror:8 row_mask:0xf bank_mask:0xf
    s_nop 1
    v_max_f32_dpp v155, v155, v155 row_ror:4 row_mask:0xf bank_mask:0xf
    s_nop 1
    v_max_f32_dpp v155, v155, v155 row_ror:2 row_mask:0xf bank_mask:0xf
    s_nop 1
    v_max_f32_dpp v155, v155, v155 row_ror:1 row_mask:0xf bank_mask:0xf
    v_max_f32 v155, v155, v152
    v_sub_f32 v156, v152, v155
    v_sub_f32 v157, v154, v155
    v_exp_f32 v156, v156
    v_exp_f32 v157, v157
    v_mov_b32 v152, v155
    v_fma_f32 v153, v153, v156, v157
    ds_bpermute_b32 v160, v172, v157
    ds_bpermute_b32 v161, v173, v157
    ds_bpermute_b32 v162, v174, v157
    ds_bpermute_b32 v163, v175, v157
    ds_bpermute_b32 v164, v176, v157
    ds_bpermute_b32 v165, v177, v157
    ds_bpermute_b32 v166, v178, v157
    ds_bpermute_b32 v167, v179, v157
    v_mul_f32 v144, v144, v156
    v_mul_f32 v145, v145, v156
    v_mul_f32 v146, v146, v156
    v_mul_f32 v147, v147, v156
    v_mul_f32 v148, v148, v156
    v_mul_f32 v149, v149, v156
    v_mul_f32 v150, v150, v156
    v_mul_f32 v151, v151, v156
    s_waitcnt lgkmcnt(0)
    s_waitcnt vmcnt(26)
    v_lshlrev_b32 v158, 16, v56
    v_and_b32 v159, 0xffff0000, v56
    v_fmac_f32 v144, v158, v160
    v_fmac_f32 v145, v159, v160
    v_lshlrev_b32 v158, 16, v57
    v_and_b32 v159, 0xffff0000, v57
    v_fmac_f32 v146, v158, v160
    v_fmac_f32 v147, v159, v160
    v_lshlrev_b32 v158, 16, v58
    v_and_b32 v159, 0xffff0000, v58
    v_fmac_f32 v148, v158, v160
    v_fmac_f32 v149, v159, v160
    v_lshlrev_b32 v158, 16, v59
    v_and_b32 v159, 0xffff0000, v59
    v_fmac_f32 v150, v158, v160
    v_fmac_f32 v151, v159, v160
    s_waitcnt vmcnt(25)
    v_lshlrev_b32 v158, 16, v60
    v_and_b32 v159, 0xffff0000, v60
    v_fmac_f32 v144, v158, v161
    v_fmac_f32 v145, v159, v161
    v_lshlrev_b32 v158, 16, v61
    v_and_b32 v159, 0xffff0000, v61
    v_fmac_f32 v146, v158, v161
    v_fmac_f32 v147, v159, v161
    v_lshlrev_b32 v158, 16, v62
    v_and_b32 v159, 0xffff0000, v62
    v_fmac_f32 v148, v158, v161
    v_fmac_f32 v149, v159, v161
    v_lshlrev_b32 v158, 16, v63
    v_and_b32 v159, 0xffff0000, v63
    v_fmac_f32 v150, v158, v161
    v_fmac_f32 v151, v159, v161
    s_waitcnt vmcnt(24)
    v_lshlrev_b32 v158, 16, v64
    v_and_b32 v159, 0xffff0000, v64
    v_fmac_f32 v144, v158, v162
    v_fmac_f32 v145, v159, v162
    v_lshlrev_b32 v158, 16, v65
    v_and_b32 v159, 0xffff0000, v65
    v_fmac_f32 v146, v158, v162
    v_fmac_f32 v147, v159, v162
    v_lshlrev_b32 v158, 16, v66
    v_and_b32 v159, 0xffff0000, v66
    v_fmac_f32 v148, v158, v162
    v_fmac_f32 v149, v159, v162
    v_lshlrev_b32 v158, 16, v67
    v_and_b32 v159, 0xffff0000, v67
    v_fmac_f32 v150, v158, v162
    v_fmac_f32 v151, v159, v162
    s_waitcnt vmcnt(23)
    v_lshlrev_b32 v158, 16, v68
    v_and_b32 v159, 0xffff0000, v68
    v_fmac_f32 v144, v158, v163
    v_fmac_f32 v145, v159, v163
    v_lshlrev_b32 v158, 16, v69
    v_and_b32 v159, 0xffff0000, v69
    v_fmac_f32 v146, v158, v163
    v_fmac_f32 v147, v159, v163
    v_lshlrev_b32 v158, 16, v70
    v_and_b32 v159, 0xffff0000, v70
    v_fmac_f32 v148, v158, v163
    v_fmac_f32 v149, v159, v163
    v_lshlrev_b32 v158, 16, v71
    v_and_b32 v159, 0xffff0000, v71
    v_fmac_f32 v150, v158, v163
    v_fmac_f32 v151, v159, v163
    s_waitcnt vmcnt(22)
    v_lshlrev_b32 v158, 16, v72
    v_and_b32 v159, 0xffff0000, v72
    v_fmac_f32 v144, v158, v164
    v_fmac_f32 v145, v159, v164
    v_lshlrev_b32 v158, 16, v73
    v_and_b32 v159, 0xffff0000, v73
    v_fmac_f32 v146, v158, v164
    v_fmac_f32 v147, v159, v164
    v_lshlrev_b32 v158, 16, v74
    v_and_b32 v159, 0xffff0000, v74
    v_fmac_f32 v148, v158, v164
    v_fmac_f32 v149, v159, v164
    v_lshlrev_b32 v158, 16, v75
    v_and_b32 v159, 0xffff0000, v75
    v_fmac_f32 v150, v158, v164
    v_fmac_f32 v151, v159, v164
    s_waitcnt vmcnt(21)
    v_lshlrev_b32 v158, 16, v76
    v_and_b32 v159, 0xffff0000, v76
    v_fmac_f32 v144, v158, v165
    v_fmac_f32 v145, v159, v165
    v_lshlrev_b32 v158, 16, v77
    v_and_b32 v159, 0xffff0000, v77
    v_fmac_f32 v146, v158, v165
    v_fmac_f32 v147, v159, v165
    v_lshlrev_b32 v158, 16, v78
    v_and_b32 v159, 0xffff0000, v78
    v_fmac_f32 v148, v158, v165
    v_fmac_f32 v149, v159, v165
    v_lshlrev_b32 v158, 16, v79
    v_and_b32 v159, 0xffff0000, v79
    v_fmac_f32 v150, v158, v165
    v_fmac_f32 v151, v159, v165
    s_waitcnt vmcnt(20)
    v_lshlrev_b32 v158, 16, v80
    v_and_b32 v159, 0xffff0000, v80
    v_fmac_f32 v144, v158, v166
    v_fmac_f32 v145, v159, v166
    v_lshlrev_b32 v158, 16, v81
    v_and_b32 v159, 0xffff0000, v81
    v_fmac_f32 v146, v158, v166
    v_fmac_f32 v147, v159, v166
    v_lshlrev_b32 v158, 16, v82
    v_and_b32 v159, 0xffff0000, v82
    v_fmac_f32 v148, v158, v166
    v_fmac_f32 v149, v159, v166
    v_lshlrev_b32 v158, 16, v83
    v_and_b32 v159, 0xffff0000, v83
    v_fmac_f32 v150, v158, v166
    v_fmac_f32 v151, v159, v166
    s_waitcnt vmcnt(19)
    v_lshlrev_b32 v158, 16, v84
    v_and_b32 v159, 0xffff0000, v84
    v_fmac_f32 v144, v158, v167
    v_fmac_f32 v145, v159, v167
    v_lshlrev_b32 v158, 16, v85
    v_and_b32 v159, 0xffff0000, v85
    v_fmac_f32 v146, v158, v167
    v_fmac_f32 v147, v159, v167
    v_lshlrev_b32 v158, 16, v86
    v_and_b32 v159, 0xffff0000, v86
    v_fmac_f32 v148, v158, v167
    v_fmac_f32 v149, v159, v167
    v_lshlrev_b32 v158, 16, v87
    v_and_b32 v159, 0xffff0000, v87
    v_fmac_f32 v150, v158, v167
    v_fmac_f32 v151, v159, v167
    s_waitcnt vmcnt(13)
    v_mfma_f32_16x16x32_bf16 v[168:171], v[8:11], v[88:91], 0
    v_mfma_f32_16x16x32_bf16 v[168:171], v[12:15], v[92:95], v[168:171]
    v_mfma_f32_16x16x32_bf16 v[168:171], v[16:19], v[96:99], v[168:171]
    v_mfma_f32_16x16x32_bf16 v[168:171], v[20:23], v[100:103], v[168:171]
    v_mfma_f32_16x16x32_bf16 v[168:171], v[24:27], v[104:107], v[168:171]
    v_mfma_f32_16x16x32_bf16 v[168:171], v[28:31], v[108:111], v[168:171]
    s_nop 8
    v_cvt_pk_bf16_f32 v154, v168, v168
    v_lshlrev_b32 v154, 16, v154
    v_mul_f32 v154, 0x3d93cd3a, v154
    v_cvt_pk_bf16_f32 v154, v154, v154
    v_lshlrev_b32 v154, 16, v154
    v_mul_f32 v154, 0x3fb8aa3b, v154
    s_nop 1
    v_max_f32_dpp v155, v154, v154 row_ror:8 row_mask:0xf bank_mask:0xf
    s_nop 1
    v_max_f32_dpp v155, v155, v155 row_ror:4 row_mask:0xf bank_mask:0xf
    s_nop 1
    v_max_f32_dpp v155, v155, v155 row_ror:2 row_mask:0xf bank_mask:0xf
    s_nop 1
    v_max_f32_dpp v155, v155, v155 row_ror:1 row_mask:0xf bank_mask:0xf
    v_max_f32 v155, v155, v152
    v_sub_f32 v156, v152, v155
    v_sub_f32 v157, v154, v155
    v_exp_f32 v156, v156
    v_exp_f32 v157, v157
    v_mov_b32 v152, v155
    v_fma_f32 v153, v153, v156, v157
    ds_bpermute_b32 v160, v172, v157
    ds_bpermute_b32 v161, v173, v157
    ds_bpermute_b32 v162, v174, v157
    ds_bpermute_b32 v163, v175, v157
    ds_bpermute_b32 v164, v176, v157
    ds_bpermute_b32 v165, v177, v157
    ds_bpermute_b32 v166, v178, v157
    ds_bpermute_b32 v167, v179, v157
    v_mul_f32 v144, v144, v156
    v_mul_f32 v145, v145, v156
    v_mul_f32 v146, v146, v156
    v_mul_f32 v147, v147, v156
    v_mul_f32 v148, v148, v156
    v_mul_f32 v149, v149, v156
    v_mul_f32 v150, v150, v156
    v_mul_f32 v151, v151, v156
    s_waitcnt lgkmcnt(0)
    s_waitcnt vmcnt(12)
    v_lshlrev_b32 v158, 16, v112
    v_and_b32 v159, 0xffff0000, v112
    v_fmac_f32 v144, v158, v160
    v_fmac_f32 v145, v159, v160
    v_lshlrev_b32 v158, 16, v113
    v_and_b32 v159, 0xffff0000, v113
    v_fmac_f32 v146, v158, v160
    v_fmac_f32 v147, v159, v160
    v_lshlrev_b32 v158, 16, v114
    v_and_b32 v159, 0xffff0000, v114
    v_fmac_f32 v148, v158, v160
    v_fmac_f32 v149, v159, v160
    v_lshlrev_b32 v158, 16, v115
    v_and_b32 v159, 0xffff0000, v115
    v_fmac_f32 v150, v158, v160
    v_fmac_f32 v151, v159, v160
    s_waitcnt vmcnt(11)
    v_lshlrev_b32 v158, 16, v116
    v_and_b32 v159, 0xffff0000, v116
    v_fmac_f32 v144, v158, v161
    v_fmac_f32 v145, v159, v161
    v_lshlrev_b32 v158, 16, v117
    v_and_b32 v159, 0xffff0000, v117
    v_fmac_f32 v146, v158, v161
    v_fmac_f32 v147, v159, v161
    v_lshlrev_b32 v158, 16, v118
    v_and_b32 v159, 0xffff0000, v118
    v_fmac_f32 v148, v158, v161
    v_fmac_f32 v149, v159, v161
    v_lshlrev_b32 v158, 16, v119
    v_and_b32 v159, 0xffff0000, v119
    v_fmac_f32 v150, v158, v161
    v_fmac_f32 v151, v159, v161
    s_waitcnt vmcnt(10)
    v_lshlrev_b32 v158, 16, v120
    v_and_b32 v159, 0xffff0000, v120
    v_fmac_f32 v144, v158, v162
    v_fmac_f32 v145, v159, v162
    v_lshlrev_b32 v158, 16, v121
    v_and_b32 v159, 0xffff0000, v121
    v_fmac_f32 v146, v158, v162
    v_fmac_f32 v147, v159, v162
    v_lshlrev_b32 v158, 16, v122
    v_and_b32 v159, 0xffff0000, v122
    v_fmac_f32 v148, v158, v162
    v_fmac_f32 v149, v159, v162
    v_lshlrev_b32 v158, 16, v123
    v_and_b32 v159, 0xffff0000, v123
    v_fmac_f32 v150, v158, v162
    v_fmac_f32 v151, v159, v162
    s_waitcnt vmcnt(9)
    v_lshlrev_b32 v158, 16, v124
    v_and_b32 v159, 0xffff0000, v124
    v_fmac_f32 v144, v158, v163
    v_fmac_f32 v145, v159, v163
    v_lshlrev_b32 v158, 16, v125
    v_and_b32 v159, 0xffff0000, v125
    v_fmac_f32 v146, v158, v163
    v_fmac_f32 v147, v159, v163
    v_lshlrev_b32 v158, 16, v126
    v_and_b32 v159, 0xffff0000, v126
    v_fmac_f32 v148, v158, v163
    v_fmac_f32 v149, v159, v163
    v_lshlrev_b32 v158, 16, v127
    v_and_b32 v159, 0xffff0000, v127
    v_fmac_f32 v150, v158, v163
    v_fmac_f32 v151, v159, v163
    s_waitcnt vmcnt(8)
    v_lshlrev_b32 v158, 16, v128
    v_and_b32 v159, 0xffff0000, v128
    v_fmac_f32 v144, v158, v164
    v_fmac_f32 v145, v159, v164
    v_lshlrev_b32 v158, 16, v129
    v_and_b32 v159, 0xffff0000, v129
    v_fmac_f32 v146, v158, v164
    v_fmac_f32 v147, v159, v164
    v_lshlrev_b32 v158, 16, v130
    v_and_b32 v159, 0xffff0000, v130
    v_fmac_f32 v148, v158, v164
    v_fmac_f32 v149, v159, v164
    v_lshlrev_b32 v158, 16, v131
    v_and_b32 v159, 0xffff0000, v131
    v_fmac_f32 v150, v158, v164
    v_fmac_f32 v151, v159, v164
    s_waitcnt vmcnt(7)
    v_lshlrev_b32 v158, 16, v132
    v_and_b32 v159, 0xffff0000, v132
    v_fmac_f32 v144, v158, v165
    v_fmac_f32 v145, v159, v165
    v_lshlrev_b32 v158, 16, v133
    v_and_b32 v159, 0xffff0000, v133
    v_fmac_f32 v146, v158, v165
    v_fmac_f32 v147, v159, v165
    v_lshlrev_b32 v158, 16, v134
    v_and_b32 v159, 0xffff0000, v134
    v_fmac_f32 v148, v158, v165
    v_fmac_f32 v149, v159, v165
    v_lshlrev_b32 v158, 16, v135
    v_and_b32 v159, 0xffff0000, v135
    v_fmac_f32 v150, v158, v165
    v_fmac_f32 v151, v159, v165
    s_waitcnt vmcnt(6)
    v_lshlrev_b32 v158, 16, v136
    v_and_b32 v159, 0xffff0000, v136
    v_fmac_f32 v144, v158, v166
    v_fmac_f32 v145, v159, v166
    v_lshlrev_b32 v158, 16, v137
    v_and_b32 v159, 0xffff0000, v137
    v_fmac_f32 v146, v158, v166
    v_fmac_f32 v147, v159, v166
    v_lshlrev_b32 v158, 16, v138
    v_and_b32 v159, 0xffff0000, v138
    v_fmac_f32 v148, v158, v166
    v_fmac_f32 v149, v159, v166
    v_lshlrev_b32 v158, 16, v139
    v_and_b32 v159, 0xffff0000, v139
    v_fmac_f32 v150, v158, v166
    v_fmac_f32 v151, v159, v166
    s_waitcnt vmcnt(5)
    v_lshlrev_b32 v158, 16, v140
    v_and_b32 v159, 0xffff0000, v140
    v_fmac_f32 v144, v158, v167
    v_fmac_f32 v145, v159, v167
    v_lshlrev_b32 v158, 16, v141
    v_and_b32 v159, 0xffff0000, v141
    v_fmac_f32 v146, v158, v167
    v_fmac_f32 v147, v159, v167
    v_lshlrev_b32 v158, 16, v142
    v_and_b32 v159, 0xffff0000, v142
    v_fmac_f32 v148, v158, v167
    v_fmac_f32 v149, v159, v167
    v_lshlrev_b32 v158, 16, v143
    v_and_b32 v159, 0xffff0000, v143
    v_fmac_f32 v150, v158, v167
    v_fmac_f32 v151, v159, v167
    s_mov_b32 s94, 32
    s_branch L_fin0
L_fin0:
    s_nop 1
    v_add_f32_dpp v153, v153, v153 row_ror:8 row_mask:0xf bank_mask:0xf
    s_nop 1
    v_add_f32_dpp v153, v153, v153 row_ror:4 row_mask:0xf bank_mask:0xf
    s_nop 1
    v_add_f32_dpp v153, v153, v153 row_ror:2 row_mask:0xf bank_mask:0xf
    s_nop 1
    v_add_f32_dpp v153, v153, v153 row_ror:1 row_mask:0xf bank_mask:0xf
    s_nop 1
    s_lshl_b32 s14, s10, 2
    v_mov_b32 v154, s14
    ds_write_b32 v154, v152 offset:36416
    ds_write_b32 v154, v153 offset:36480
    s_mul_i32 s14, s10, 1536
    v_lshlrev_b32 v154, 5, v1
    v_add_u32 v154, s14, v154
    v_cmp_gt_u32 vcc, 48, v1
    s_and_saveexec_b64 s[92:93], vcc
    ds_write_b128 v154, v[144:147] offset:5120
    ds_write_b128 v154, v[148:151] offset:5136
    s_or_b64 exec, exec, s[92:93]
    s_waitcnt vmcnt(0)
    v_mov_b32 v192, v32
    v_mov_b32 v193, v33
    v_mov_b32 v194, v34
    v_mov_b32 v195, v35
    v_mov_b32 v196, v36
    v_mov_b32 v197, v37
    v_mov_b32 v198, v38
    v_mov_b32 v199, v39
    v_mov_b32 v200, v40
    v_mov_b32 v201, v41
    v_mov_b32 v202, v42
    v_mov_b32 v203, v43
    v_mov_b32 v204, v44
    v_mov_b32 v205, v45
    v_mov_b32 v206, v46
    v_mov_b32 v207, v47
    v_mov_b32 v208, v48
    v_mov_b32 v209, v49
    v_mov_b32 v210, v50
    v_mov_b32 v211, v51
    s_branch L_common
L_fin1:
    s_nop 1
    v_add_f32_dpp v153, v153, v153 row_ror:8 row_mask:0xf bank_mask:0xf
    s_nop 1
    v_add_f32_dpp v153, v153, v153 row_ror:4 row_mask:0xf bank_mask:0xf
    s_nop 1
    v_add_f32_dpp v153, v153, v153 row_ror:2 row_mask:0xf bank_mask:0xf
    s_nop 1
    v_add_f32_dpp v153, v153, v153 row_ror:1 row_mask:0xf bank_mask:0xf
    s_nop 1
    s_lshl_b32 s14, s10, 2
    v_mov_b32 v154, s14
    ds_write_b32 v154, v152 offset:36416
    ds_write_b32 v154, v153 offset:36480
    s_mul_i32 s14, s10, 1536
    v_lshlrev_b32 v154, 5, v1
    v_add_u32 v154, s14, v154
    v_cmp_gt_u32 vcc, 48, v1
    s_and_saveexec_b64 s[92:93], vcc
    ds_write_b128 v154, v[144:147] offset:5120
    ds_write_b128 v154, v[148:151] offset:5136
    s_or_b64 exec, exec, s[92:93]
    s_waitcnt vmcnt(0)
    v_mov_b32 v192, v88
    v_mov_b32 v193, v89
    v_mov_b32 v194, v90
    v_mov_b32 v195, v91
    v_mov_b32 v196, v92
    v_mov_b32 v197, v93
    v_mov_b32 v198, v94
    v_mov_b32 v199, v95
    v_mov_b32 v200, v96
    v_mov_b32 v201, v97
    v_mov_b32 v202, v98
    v_mov_b32 v203, v99
    v_mov_b32 v204, v100
    v_mov_b32 v205, v101
    v_mov_b32 v206, v102
    v_mov_b32 v207, v103
    v_mov_b32 v208, v104
    v_mov_b32 v209, v105
    v_mov_b32 v210, v106
    v_mov_b32 v211, v107
L_common:
    s_waitcnt lgkmcnt(0)
    s_barrier
    v_cmp_gt_u32 vcc, 192, v0
    s_and_saveexec_b64 s[92:93], vcc
    s_cbranch_execz L_rec_done
    v_mov_b32 v154, 0
    v_lshlrev_b32 v155, 2, v0
    ds_read_b32 v56, v154 offset:36416
    ds_read_b32 v64, v154 offset:36480
    ds_read_b32 v72, v155 offset:5120
    ds_read_b32 v73, v155 offset:5888
    ds_read_b32 v57, v154 offset:36420
    ds_read_b32 v65, v154 offset:36484
    ds_read_b32 v74, v155 offset:6656
    ds_read_b32 v75, v155 offset:7424
    ds_read_b32 v58, v154 offset:36424
    ds_read_b32 v66, v154 offset:36488
    ds_read_b32 v76, v155 offset:8192
    ds_read_b32 v77, v155 offset:8960
    ds_read_b32 v59, v154 offset:36428
    ds_read_b32 v67, v154 offset:36492
    ds_read_b32 v78, v155 offset:9728
    ds_read_b32 v79, v155 offset:10496
    ds_read_b32 v60, v154 offset:36432
    ds_read_b32 v68, v154 offset:36496
    ds_read_b32 v80, v155 offset:11264
    ds_read_b32 v81, v155 offset:12032
    ds_read_b32 v61, v154 offset:36436
    ds_read_b32 v69, v154 offset:36500
    ds_read_b32 v82, v155 offset:12800
    ds_read_b32 v83, v155 offset:13568
    ds_read_b32 v62, v154 offset:36440
    ds_read_b32 v70, v154 offset:36504
    ds_read_b32 v84, v155 offset:14336
    ds_read_b32 v85, v155 offset:15104
    ds_read_b32 v63, v154 offset:36444
    ds_read_b32 v71, v154 offset:36508
    ds_read_b32 v86, v155 offset:15872
    ds_read_b32 v87, v155 offset:16640
    s_waitcnt lgkmcnt(0)
    v_mov_b32 v156, v56
    v_max_f32 v156, v156, v57
    v_max_f32 v156, v156, v58
    v_max_f32 v156, v156, v59
    v_max_f32 v156, v156, v60
    v_max_f32 v156, v156, v61
    v_max_f32 v156, v156, v62
    v_max_f32 v156, v156, v63
    v_mov_b32 v157, 0
    v_mov_b32 v158, 0
    v_sub_f32 v159, v56, v156
    v_exp_f32 v159, v159
    v_add_f32 v160, v72, v73
    v_fmac_f32 v157, v159, v64
    v_fmac_f32 v158, v159, v160
    v_sub_f32 v159, v57, v156
    v_exp_f32 v159, v159
    v_add_f32 v160, v74, v75
    v_fmac_f32 v157, v159, v65
    v_fmac_f32 v158, v159, v160
    v_sub_f32 v159, v58, v156
    v_exp_f32 v159, v159
    v_add_f32 v160, v76, v77
    v_fmac_f32 v157, v159, v66
    v_fmac_f32 v158, v159, v160
    v_sub_f32 v159, v59, v156
    v_exp_f32 v159, v159
    v_add_f32 v160, v78, v79
    v_fmac_f32 v157, v159, v67
    v_fmac_f32 v158, v159, v160
    v_sub_f32 v159, v60, v156
    v_exp_f32 v159, v159
    v_add_f32 v160, v80, v81
    v_fmac_f32 v157, v159, v68
    v_fmac_f32 v158, v159, v160
    v_sub_f32 v159, v61, v156
    v_exp_f32 v159, v159
    v_add_f32 v160, v82, v83
    v_fmac_f32 v157, v159, v69
    v_fmac_f32 v158, v159, v160
    v_sub_f32 v159, v62, v156
    v_exp_f32 v159, v159
    v_add_f32 v160, v84, v85
    v_fmac_f32 v157, v159, v70
    v_fmac_f32 v158, v159, v160
    v_sub_f32 v159, v63, v156
    v_exp_f32 v159, v159
    v_add_f32 v160, v86, v87
    v_fmac_f32 v157, v159, v71
    v_fmac_f32 v158, v159, v160
    s_lshl_b32 s14, s2, 10
    s_add_u32 s14, s14, 65536
    buffer_store_dword v158, v155, s[24:27], s14 offen sc1
    v_cmp_eq_u32 vcc, 0, v0
    s_and_saveexec_b64 s[100:101], vcc
    buffer_store_dword v156, v155, s[24:27], s14 offen offset:768 sc1
    buffer_store_dword v157, v155, s[24:27], s14 offen offset:772 sc1
    s_mov_b64 exec, s[100:101]
    s_lshl_b32 s15, s11, 13
    s_add_u32 s15, s15, 65536
    v_mov_b32 v154, 0
    s_mov_b32 s94, 0
L_poll:
    s_mov_b32 s14, s15
    buffer_load_dword v56, v155, s[24:27], s14 offen offset:0 sc1
    buffer_load_dwordx2 v[64:65], v154, s[24:27], s14 offen offset:768 sc1
    buffer_load_dword v57, v155, s[24:27], s14 offen offset:1024 sc1
    buffer_load_dwordx2 v[66:67], v154, s[24:27], s14 offen offset:1792 sc1
    buffer_load_dword v58, v155, s[24:27], s14 offen offset:2048 sc1
    buffer_load_dwordx2 v[68:69], v154, s[24:27], s14 offen offset:2816 sc1
    buffer_load_dword v59, v155, s[24:27], s14 offen offset:3072 sc1
    buffer_load_dwordx2 v[70:71], v154, s[24:27], s14 offen offset:3840 sc1
    s_add_u32 s14, s14, 4096
    buffer_load_dword v60, v155, s[24:27], s14 offen offset:0 sc1
    buffer_load_dwordx2 v[72:73], v154, s[24:27], s14 offen offset:768 sc1
    buffer_load_dword v61, v155, s[24:27], s14 offen offset:1024 sc1
    buffer_load_dwordx2 v[74:75], v154, s[24:27], s14 offen offset:1792 sc1
    buffer_load_dword v62, v155, s[24:27], s14 offen offset:2048 sc1
    buffer_load_dwordx2 v[76:77], v154, s[24:27], s14 offen offset:2816 sc1
    buffer_load_dword v63, v155, s[24:27], s14 offen offset:3072 sc1
    buffer_load_dwordx2 v[78:79], v154, s[24:27], s14 offen offset:3840 sc1
    s_waitcnt vmcnt(0)
    v_and_b32 v156, v56, v57
    v_max_u32 v156, v56, v57
    v_max_u32 v156, v156, v58
    v_max_u32 v156, v156, v59
    v_max_u32 v156, v156, v60
    v_max_u32 v156, v156, v61
    v_max_u32 v156, v156, v62
    v_max_u32 v156, v156, v63
    v_max_u32 v156, v156, v64
    v_max_u32 v156, v156, v65
    v_max_u32 v156, v156, v66
    v_max_u32 v156, v156, v67
    v_max_u32 v156, v156, v68
    v_max_u32 v156, v156, v69
    v_max_u32 v156, v156, v70
    v_max_u32 v156, v156, v71
    v_max_u32 v156, v156, v72
    v_max_u32 v156, v156, v73
    v_max_u32 v156, v156, v74
    v_max_u32 v156, v156, v75
    v_max_u32 v156, v156, v76
    v_max_u32 v156, v156, v77
    v_max_u32 v156, v156, v78
    v_max_u32 v156, v156, v79
    v_cmp_eq_u32 vcc, -1, v156
    s_cbranch_vccz L_poll_done
    s_sleep 1
    s_add_u32 s94, s94, 1
    s_cmp_lt_u32 s94, 0x100000
    s_cbranch_scc1 L_poll
L_poll_done:
    v_mov_b32 v156, v64
    v_max_f32 v156, v156, v66
    v_max_f32 v156, v156, v68
    v_max_f32 v156, v156, v70
    v_max_f32 v156, v156, v72
    v_max_f32 v156, v156, v74
    v_max_f32 v156, v156, v76
    v_max_f32 v156, v156, v78
    v_mov_b32 v157, 0
    v_mov_b32 v158, 0
    v_sub_f32 v159, v64, v156
    v_exp_f32 v159, v159
    s_nop 0
    v_fmac_f32 v157, v159, v65
    v_fmac_f32 v158, v159, v56
    v_sub_f32 v159, v66, v156
    v_exp_f32 v159, v159
    s_nop 0
    v_fmac_f32 v157, v159, v67
    v_fmac_f32 v158, v159, v57
    v_sub_f32 v159, v68, v156
    v_exp_f32 v159, v159
    s_nop 0
    v_fmac_f32 v157, v159, v69
    v_fmac_f32 v158, v159, v58
    v_sub_f32 v159, v70, v156
    v_exp_f32 v159, v159
    s_nop 0
    v_fmac_f32 v157, v159, v71
    v_fmac_f32 v158, v159, v59
    v_sub_f32 v159, v72, v156
    v_exp_f32 v159, v159
    s_nop 0
    v_fmac_f32 v157, v159, v73
    v_fmac_f32 v158, v159, v60
    v_sub_f32 v159, v74, v156
    v_exp_f32 v159, v159
    s_nop 0
    v_fmac_f32 v157, v159, v75
    v_fmac_f32 v158, v159, v61
    v_sub_f32 v159, v76, v156
    v_exp_f32 v159, v159
    s_nop 0
    v_fmac_f32 v157, v159, v77
    v_fmac_f32 v158, v159, v62
    v_sub_f32 v159, v78, v156
    v_exp_f32 v159, v159
    s_nop 0
    v_fmac_f32 v157, v159, v79
    v_fmac_f32 v158, v159, v63
    v_rcp_f32 v159, v157
    s_nop 1
    v_fma_f32 v156, -v157, v159, 1.0
    v_fmac_f32 v159, v156, v159
    v_mul_f32 v158, v158, v159
    v_cvt_pk_bf16_f32 v158, v158, v158
    v_lshlrev_b32 v158, 16, v158
    ds_write_b32 v155, v158 offset:36544
L_rec_done:
    s_mov_b64 exec, -1
    s_waitcnt lgkmcnt(0)
    s_barrier
    v_lshlrev_b32 v5, 2, v180
    ds_read_b32 v56, v5 offset:36544
    ds_read_b32 v57, v5 offset:36736
    ds_read_b32 v58, v5 offset:36928
    ds_read_b32 v59, v5 offset:37120
    ds_read_b32 v60, v5 offset:36224
    v_mov_b32 v144, 0
    v_mov_b32 v145, 0
    v_mov_b32 v146, 0
    v_mov_b32 v147, 0
    v_mov_b32 v148, 0
    v_mov_b32 v149, 0
    v_mov_b32 v150, 0
    v_mov_b32 v151, 0
    s_waitcnt lgkmcnt(0)
    v_lshlrev_b32 v158, 16, v192
    v_and_b32 v159, 0xffff0000, v192
    v_fmac_f32 v144, v158, v56
    v_fmac_f32 v145, v159, v56
    v_lshlrev_b32 v158, 16, v193
    v_and_b32 v159, 0xffff0000, v193
    v_fmac_f32 v146, v158, v56
    v_fmac_f32 v147, v159, v56
    v_lshlrev_b32 v158, 16, v194
    v_and_b32 v159, 0xffff0000, v194
    v_fmac_f32 v148, v158, v56
    v_fmac_f32 v149, v159, v56
    v_lshlrev_b32 v158, 16, v195
    v_and_b32 v159, 0xffff0000, v195
    v_fmac_f32 v150, v158, v56
    v_fmac_f32 v151, v159, v56
    v_lshlrev_b32 v158, 16, v196
    v_and_b32 v159, 0xffff0000, v196
    v_fmac_f32 v144, v158, v57
    v_fmac_f32 v145, v159, v57
    v_lshlrev_b32 v158, 16, v197
    v_and_b32 v159, 0xffff0000, v197
    v_fmac_f32 v146, v158, v57
    v_fmac_f32 v147, v159, v57
    v_lshlrev_b32 v158, 16, v198
    v_and_b32 v159, 0xffff0000, v198
    v_fmac_f32 v148, v158, v57
    v_fmac_f32 v149, v159, v57
    v_lshlrev_b32 v158, 16, v199
    v_and_b32 v159, 0xffff0000, v199
    v_fmac_f32 v150, v158, v57
    v_fmac_f32 v151, v159, v57
    v_lshlrev_b32 v158, 16, v200
    v_and_b32 v159, 0xffff0000, v200
    v_fmac_f32 v144, v158, v58
    v_fmac_f32 v145, v159, v58
    v_lshlrev_b32 v158, 16, v201
    v_and_b32 v159, 0xffff0000, v201
    v_fmac_f32 v146, v158, v58
    v_fmac_f32 v147, v159, v58
    v_lshlrev_b32 v158, 16, v202
    v_and_b32 v159, 0xffff0000, v202
    v_fmac_f32 v148, v158, v58
    v_fmac_f32 v149, v159, v58
    v_lshlrev_b32 v158, 16, v203
    v_and_b32 v159, 0xffff0000, v203
    v_fmac_f32 v150, v158, v58
    v_fmac_f32 v151, v159, v58
    v_lshlrev_b32 v158, 16, v204
    v_and_b32 v159, 0xffff0000, v204
    v_fmac_f32 v144, v158, v59
    v_fmac_f32 v145, v159, v59
    v_lshlrev_b32 v158, 16, v205
    v_and_b32 v159, 0xffff0000, v205
    v_fmac_f32 v146, v158, v59
    v_fmac_f32 v147, v159, v59
    v_lshlrev_b32 v158, 16, v206
    v_and_b32 v159, 0xffff0000, v206
    v_fmac_f32 v148, v158, v59
    v_fmac_f32 v149, v159, v59
    v_lshlrev_b32 v158, 16, v207
    v_and_b32 v159, 0xffff0000, v207
    v_fmac_f32 v150, v158, v59
    v_fmac_f32 v151, v159, v59
    v_lshlrev_b32 v158, 16, v208
    v_and_b32 v159, 0xffff0000, v208
    v_mul_f32 v160, v158, v60
    v_mul_f32 v161, v159, v60
    v_lshlrev_b32 v158, 16, v209
    v_and_b32 v159, 0xffff0000, v209
    v_mul_f32 v162, v158, v60
    v_mul_f32 v163, v159, v60
    v_lshlrev_b32 v158, 16, v210
    v_and_b32 v159, 0xffff0000, v210
    v_mul_f32 v164, v158, v60
    v_mul_f32 v165, v159, v60
    v_lshlrev_b32 v158, 16, v211
    v_and_b32 v159, 0xffff0000, v211
    v_mul_f32 v166, v158, v60
    v_mul_f32 v167, v159, v60
    v_mul_u32_u24 v5, 640, v180
    v_lshlrev_b32 v154, 5, v181
    v_add_u32 v5, v5, v154
    v_cmp_gt_u32 vcc, 480, v0
    s_and_saveexec_b64 s[92:93], vcc
    ds_write_b128 v5, v[144:147] offset:5120
    ds_write_b128 v5, v[148:151] offset:5136
    ds_write_b128 v5, v[160:163] offset:5440
    ds_write_b128 v5, v[164:167] offset:5456
    s_or_b64 exec, exec, s[92:93]
    s_waitcnt lgkmcnt(0)
    s_barrier
    v_cmp_gt_u32 vcc, 160, v0
    s_and_saveexec_b64 s[92:93], vcc
    s_cbranch_execz L_outp_done
    v_lshlrev_b32 v5, 2, v0
    ds_read_b32 v56, v5 offset:5120
    ds_read_b32 v57, v5 offset:5760
    ds_read_b32 v58, v5 offset:6400
    ds_read_b32 v59, v5 offset:7040
    ds_read_b32 v60, v5 offset:7680
    ds_read_b32 v61, v5 offset:8320
    ds_read_b32 v62, v5 offset:8960
    ds_read_b32 v63, v5 offset:9600
    ds_read_b32 v64, v5 offset:10240
    ds_read_b32 v65, v5 offset:10880
    ds_read_b32 v66, v5 offset:11520
    ds_read_b32 v67, v5 offset:12160
    ds_read_b32 v68, v5 offset:12800
    ds_read_b32 v69, v5 offset:13440
    ds_read_b32 v70, v5 offset:14080
    ds_read_b32 v71, v5 offset:14720
    ds_read_b32 v72, v5 offset:15360
    ds_read_b32 v73, v5 offset:16000
    ds_read_b32 v74, v5 offset:16640
    ds_read_b32 v75, v5 offset:17280
    ds_read_b32 v76, v5 offset:17920
    ds_read_b32 v77, v5 offset:18560
    ds_read_b32 v78, v5 offset:19200
    ds_read_b32 v79, v5 offset:19840
    s_waitcnt lgkmcnt(0)
    v_mov_b32 v154, v56
    v_add_f32 v154, v154, v57
    v_add_f32 v154, v154, v58
    v_add_f32 v154, v154, v59
    v_add_f32 v154, v154, v60
    v_add_f32 v154, v154, v61
    v_add_f32 v154, v154, v62
    v_add_f32 v154, v154, v63
    v_add_f32 v154, v154, v64
    v_add_f32 v154, v154, v65
    v_add_f32 v154, v154, v66
    v_add_f32 v154, v154, v67
    v_add_f32 v154, v154, v68
    v_add_f32 v154, v154, v69
    v_add_f32 v154, v154, v70
    v_add_f32 v154, v154, v71
    v_add_f32 v154, v154, v72
    v_add_f32 v154, v154, v73
    v_add_f32 v154, v154, v74
    v_add_f32 v154, v154, v75
    v_add_f32 v154, v154, v76
    v_add_f32 v154, v154, v77
    v_add_f32 v154, v154, v78
    v_add_f32 v154, v154, v79
    ds_read_b32 v56, v5 offset:20480
    ds_read_b32 v57, v5 offset:21120
    ds_read_b32 v58, v5 offset:21760
    ds_read_b32 v59, v5 offset:22400
    ds_read_b32 v60, v5 offset:23040
    ds_read_b32 v61, v5 offset:23680
    ds_read_b32 v62, v5 offset:24320
    ds_read_b32 v63, v5 offset:24960
    ds_read_b32 v64, v5 offset:25600
    ds_read_b32 v65, v5 offset:26240
    ds_read_b32 v66, v5 offset:26880
    ds_read_b32 v67, v5 offset:27520
    ds_read_b32 v68, v5 offset:28160
    ds_read_b32 v69, v5 offset:28800
    ds_read_b32 v70, v5 offset:29440
    ds_read_b32 v71, v5 offset:30080
    ds_read_b32 v72, v5 offset:30720
    ds_read_b32 v73, v5 offset:31360
    ds_read_b32 v74, v5 offset:32000
    ds_read_b32 v75, v5 offset:32640
    ds_read_b32 v76, v5 offset:33280
    ds_read_b32 v77, v5 offset:33920
    ds_read_b32 v78, v5 offset:34560
    ds_read_b32 v79, v5 offset:35200
    s_waitcnt lgkmcnt(0)
    v_add_f32 v154, v154, v56
    v_add_f32 v154, v154, v57
    v_add_f32 v154, v154, v58
    v_add_f32 v154, v154, v59
    v_add_f32 v154, v154, v60
    v_add_f32 v154, v154, v61
    v_add_f32 v154, v154, v62
    v_add_f32 v154, v154, v63
    v_add_f32 v154, v154, v64
    v_add_f32 v154, v154, v65
    v_add_f32 v154, v154, v66
    v_add_f32 v154, v154, v67
    v_add_f32 v154, v154, v68
    v_add_f32 v154, v154, v69
    v_add_f32 v154, v154, v70
    v_add_f32 v154, v154, v71
    v_add_f32 v154, v154, v72
    v_add_f32 v154, v154, v73
    v_add_f32 v154, v154, v74
    v_add_f32 v154, v154, v75
    v_add_f32 v154, v154, v76
    v_add_f32 v154, v154, v77
    v_add_f32 v154, v154, v78
    v_add_f32 v154, v154, v79
    s_mul_i32 s14, s12, 20480
    s_mul_i32 s15, s11, 640
    s_add_u32 s14, s14, s15
    s_add_u32 s14, s14, 327680
    buffer_store_dword v154, v5, s[24:27], s14 offen sc1
L_outp_done:
    s_mov_b64 exec, -1
    s_cmp_lg_u32 s11, 0
    s_cbranch_scc1 L_done
    v_cmp_gt_u32 vcc, 160, v0
    s_and_saveexec_b64 s[92:93], vcc
    v_lshlrev_b32 v5, 2, v0
    s_mul_i32 s15, s12, 20480
    s_add_u32 s15, s15, 327680
    v_subrev_u32 v155, 80, v0
    v_cmp_gt_u32 vcc, 80, v0
    s_nop 1
    v_cndmask_b32 v155, v155, v0, vcc
    v_lshlrev_b32 v155, 1, v155
    s_mul_i32 s14, s12, 160
    buffer_load_ushort v160, v155, s[36:39], s14 offen
    buffer_load_ushort v161, v155, s[52:55], s14 offen
    s_cbranch_execz L_fpoll_done
    s_mov_b32 s94, 0
L_fpoll:
    s_mov_b32 s14, s15
    buffer_load_dword v32, v5, s[24:27], s14 offen offset:0 sc1
    buffer_load_dword v33, v5, s[24:27], s14 offen offset:640 sc1
    buffer_load_dword v34, v5, s[24:27], s14 offen offset:1280 sc1
    buffer_load_dword v35, v5, s[24:27], s14 offen offset:1920 sc1
    s_add_u32 s14, s14, 2560
    buffer_load_dword v36, v5, s[24:27], s14 offen offset:0 sc1
    buffer_load_dword v37, v5, s[24:27], s14 offen offset:640 sc1
    buffer_load_dword v38, v5, s[24:27], s14 offen offset:1280 sc1
    buffer_load_dword v39, v5, s[24:27], s14 offen offset:1920 sc1
    s_add_u32 s14, s14, 2560
    buffer_load_dword v40, v5, s[24:27], s14 offen offset:0 sc1
    buffer_load_dword v41, v5, s[24:27], s14 offen offset:640 sc1
    buffer_load_dword v42, v5, s[24:27], s14 offen offset:1280 sc1
    buffer_load_dword v43, v5, s[24:27], s14 offen offset:1920 sc1
    s_add_u32 s14, s14, 2560
    buffer_load_dword v44, v5, s[24:27], s14 offen offset:0 sc1
    buffer_load_dword v45, v5, s[24:27], s14 offen offset:640 sc1
    buffer_load_dword v46, v5, s[24:27], s14 offen offset:1280 sc1
    buffer_load_dword v47, v5, s[24:27], s14 offen offset:1920 sc1
    s_add_u32 s14, s14, 2560
    buffer_load_dword v48, v5, s[24:27], s14 offen offset:0 sc1
    buffer_load_dword v49, v5, s[24:27], s14 offen offset:640 sc1
    buffer_load_dword v50, v5, s[24:27], s14 offen offset:1280 sc1
    buffer_load_dword v51, v5, s[24:27], s14 offen offset:1920 sc1
    s_add_u32 s14, s14, 2560
    buffer_load_dword v52, v5, s[24:27], s14 offen offset:0 sc1
    buffer_load_dword v53, v5, s[24:27], s14 offen offset:640 sc1
    buffer_load_dword v54, v5, s[24:27], s14 offen offset:1280 sc1
    buffer_load_dword v55, v5, s[24:27], s14 offen offset:1920 sc1
    s_add_u32 s14, s14, 2560
    buffer_load_dword v56, v5, s[24:27], s14 offen offset:0 sc1
    buffer_load_dword v57, v5, s[24:27], s14 offen offset:640 sc1
    buffer_load_dword v58, v5, s[24:27], s14 offen offset:1280 sc1
    buffer_load_dword v59, v5, s[24:27], s14 offen offset:1920 sc1
    s_add_u32 s14, s14, 2560
    buffer_load_dword v60, v5, s[24:27], s14 offen offset:0 sc1
    buffer_load_dword v61, v5, s[24:27], s14 offen offset:640 sc1
    buffer_load_dword v62, v5, s[24:27], s14 offen offset:1280 sc1
    buffer_load_dword v63, v5, s[24:27], s14 offen offset:1920 sc1
    s_waitcnt vmcnt(0)
    v_max_u32 v156, v32, v33
    v_max_u32 v156, v156, v34
    v_max_u32 v156, v156, v35
    v_max_u32 v156, v156, v36
    v_max_u32 v156, v156, v37
    v_max_u32 v156, v156, v38
    v_max_u32 v156, v156, v39
    v_max_u32 v156, v156, v40
    v_max_u32 v156, v156, v41
    v_max_u32 v156, v156, v42
    v_max_u32 v156, v156, v43
    v_max_u32 v156, v156, v44
    v_max_u32 v156, v156, v45
    v_max_u32 v156, v156, v46
    v_max_u32 v156, v156, v47
    v_max_u32 v156, v156, v48
    v_max_u32 v156, v156, v49
    v_max_u32 v156, v156, v50
    v_max_u32 v156, v156, v51
    v_max_u32 v156, v156, v52
    v_max_u32 v156, v156, v53
    v_max_u32 v156, v156, v54
    v_max_u32 v156, v156, v55
    v_max_u32 v156, v156, v56
    v_max_u32 v156, v156, v57
    v_max_u32 v156, v156, v58
    v_max_u32 v156, v156, v59
    v_max_u32 v156, v156, v60
    v_max_u32 v156, v156, v61
    v_max_u32 v156, v156, v62
    v_max_u32 v156, v156, v63
    v_cmp_eq_u32 vcc, -1, v156
    s_cbranch_vccz L_fpoll_done
    s_sleep 1
    s_add_u32 s94, s94, 1
    s_cmp_lt_u32 s94, 0x100000
    s_cbranch_scc1 L_fpoll
L_fpoll_done:
    s_mul_i32 s15, s12, 160
    s_waitcnt vmcnt(0)
    v_mov_b32 v156, v160
    v_mov_b32 v157, v161
    v_mov_b32 v154, v32
    v_add_f32 v154, v154, v33
    v_add_f32 v154, v154, v34
    v_add_f32 v154, v154, v35
    v_add_f32 v154, v154, v36
    v_add_f32 v154, v154, v37
    v_add_f32 v154, v154, v38
    v_add_f32 v154, v154, v39
    v_add_f32 v154, v154, v40
    v_add_f32 v154, v154, v41
    v_add_f32 v154, v154, v42
    v_add_f32 v154, v154, v43
    v_add_f32 v154, v154, v44
    v_add_f32 v154, v154, v45
    v_add_f32 v154, v154, v46
    v_add_f32 v154, v154, v47
    v_add_f32 v154, v154, v48
    v_add_f32 v154, v154, v49
    v_add_f32 v154, v154, v50
    v_add_f32 v154, v154, v51
    v_add_f32 v154, v154, v52
    v_add_f32 v154, v154, v53
    v_add_f32 v154, v154, v54
    v_add_f32 v154, v154, v55
    v_add_f32 v154, v154, v56
    v_add_f32 v154, v154, v57
    v_add_f32 v154, v154, v58
    v_add_f32 v154, v154, v59
    v_add_f32 v154, v154, v60
    v_add_f32 v154, v154, v61
    v_add_f32 v154, v154, v62
    v_add_f32 v154, v154, v63
    v_cvt_pk_bf16_f32 v154, v154, v154
    v_lshlrev_b32 v154, 16, v154
    v_lshlrev_b32 v157, 16, v157
    v_add_f32 v158, v154, v157
    v_cvt_pk_bf16_f32 v158, v158, v158
    v_lshlrev_b32 v158, 16, v158
    v_mul_f32 v159, 0xbfb8aa3b, v158
    v_exp_f32 v159, v159
    s_nop 1
    v_add_f32 v159, 1.0, v159
    v_rcp_f32 v159, v159
    s_nop 1
    v_mul_f32 v158, v158, v159
    v_cvt_pk_bf16_f32 v158, v158, v158
    v_lshlrev_b32 v158, 16, v158
    ds_write_b32 v5, v158 offset:5120
    s_or_b64 exec, exec, s[92:93]
    s_waitcnt lgkmcnt(0)
    s_barrier
    v_cmp_gt_u32 vcc, 80, v0
    s_and_saveexec_b64 s[92:93], vcc
    s_cbranch_execz L_done
    ds_read_b32 v158, v5 offset:5440
    s_waitcnt lgkmcnt(0)
    v_mul_f32 v154, v154, v158
    v_cvt_pk_bf16_f32 v154, v154, v154
    v_lshlrev_b32 v154, 16, v154
    v_lshlrev_b32 v156, 16, v156
    v_add_f32 v154, v154, v156
    v_cvt_pk_bf16_f32 v154, v154, v154
    buffer_store_short v154, v155, s[56:59], s15 offen
    s_mov_b64 exec, -1
L_done:
    s_endpgm
.section .rodata,"a"
.p2align 6
.amdhsa_kernel recurrent_scan__gqa_block_cached__mixer_channel_mlp__decode_kernel
  .amdhsa_next_free_vgpr 252
  .amdhsa_next_free_sgpr 102
  .amdhsa_accum_offset 252
  .amdhsa_group_segment_fixed_size 0
  .amdhsa_kernarg_size 104
  .amdhsa_user_sgpr_count 2
  .amdhsa_user_sgpr_kernarg_segment_ptr 1
  .amdhsa_system_sgpr_workgroup_id_x 1
.end_amdhsa_kernel
```
